```python
import torch

def _softmax(x, axis=-1):
    return torch.softmax(x, dim=axis)
def _gelu(x):
    return torch.nn.functional.gelu(x, approximate="tanh")
def _silu(x):
    return torch.nn.functional.silu(x)
def _sigmoid(x):
    return torch.sigmoid(x)
def _layernorm(x, axis=-1, eps=1e-5):
    m = x.mean(dim=axis, keepdim=True)
    v = x.var(dim=axis, keepdim=True, unbiased=False)
    return (x - m) / torch.sqrt(v + eps)
def _scatter_add(tgt, idx, src, axis=0):
    return tgt.clone().index_add_(axis, idx, src)
def _segment_sum(src, seg, n):
    out = torch.zeros((n,) + src.shape[1:], dtype=src.dtype)
    return out.index_add_(0, seg, src)
def _pad(x, pw):
    flat = tuple(v for pair in reversed(pw) for v in pair)
    return torch.nn.functional.pad(x, flat)

kernel_name = 'gated_mix__mha_block__linear_kernel_hedgehog__prompt'

def setup_inputs():

    _w = (lambda a: (lambda t: t.to(torch.bfloat16) if t.is_floating_point() else t)(torch.as_tensor(a)))
    def _A_setup():
        B, S, D, H = 1, 2048, 640, 32
        return {
            "x": _w((lambda *s: torch.randn(*s, dtype=torch.bfloat16) * 0.05)(B, S, D)),
            "wqkv": _w((lambda *s: torch.randn(*s, dtype=torch.bfloat16) * 0.8)(D, 3 * D)),
            "wo": _w((lambda *s: torch.randn(*s, dtype=torch.bfloat16) * 0.05)(D, D)),
        }
    _A_in = _A_setup()

    def _B_setup():
        B, S, D, H = 1, 2048, 640, 32
        Dh = D // H
        return {
            "x": _w((lambda *s: torch.randn(*s, dtype=torch.bfloat16) * 0.05)(B, S, D)),
            "wqkv": _w((lambda *s: torch.randn(*s, dtype=torch.bfloat16) * 1.6)(D, 3 * D)),
            "w_phi": _w((lambda *s: torch.randn(*s, dtype=torch.bfloat16) * 1.6)(H, Dh, Dh) * (Dh ** -0.5)),
            "wo": _w((lambda *s: torch.randn(*s, dtype=torch.bfloat16) * 0.05)(D, D)),
        }
    _B_in = _B_setup()

    return {
        "A_x": _A_in["x"],
        "A_wqkv": _A_in["wqkv"],
        "A_wo": _A_in["wo"],
        "B_x": _B_in["x"],
        "B_wqkv": _B_in["wqkv"],
        "B_w_phi": _B_in["w_phi"],
        "B_wo": _B_in["wo"],
        "gate_w": _w((lambda *s: torch.randn(*s, dtype=torch.bfloat16) * 0.05)(640) * 16.0),
    }

def reference(A_x, A_wqkv, A_wo, B_x, B_wqkv, B_w_phi, B_wo, gate_w):
    def _A_ref(x, wqkv, wo):
        B, S, D = x.shape
        H = 32
        Dh = D // H
        qkv = (lambda x, *d: x.permute(*d))((x @ wqkv).reshape(B, S, 3, H, Dh), 2, 0, 3, 1, 4)
        q, k, v = qkv[0], qkv[1], qkv[2]
        scores = torch.einsum("bhqd,bhkd->bhqk", q, k) * (Dh ** -0.5)
        p = _softmax(scores, axis=-1)
        o = torch.einsum("bhqk,bhkd->bhqd", p, v)
        return (lambda x, *d: x.permute(*d))(o, 0, 2, 1, 3).reshape(B, S, D) @ wo

    def _B_ref(x, wqkv, w_phi, wo):
        B, S, D = x.shape
        H = 32; Dh = D // H
        qkv = (lambda x, *d: x.permute(*d))((x @ wqkv).reshape(B, S, 3, H, Dh), 2, 0, 3, 1, 4)
        q, k, v = qkv[0], qkv[1], qkv[2]
        pq = torch.einsum("bhsd,hdf->bhsf", q, w_phi)
        pk = torch.einsum("bhsd,hdf->bhsf", k, w_phi)
        phi_q = torch.concatenate([_softmax(pq, axis=-1), _softmax(-pq, axis=-1)], axis=-1)
        phi_k = torch.concatenate([_softmax(pk, axis=-1), _softmax(-pk, axis=-1)], axis=-1)
        kv = torch.einsum("bhsf,bhsd->bhfd", phi_k, v)
        z  = torch.einsum("bhsf->bhf", phi_k)
        num = torch.einsum("bhqf,bhfd->bhqd", phi_q, kv)
        den = torch.einsum("bhqf,bhf->bhq", phi_q, z)[..., None] + 1e-6
        o = num / den
        return (lambda x, *d: x.permute(*d))(o, 0, 2, 1, 3).reshape(B, S, D) @ wo

    x = A_x
    g = _sigmoid((x * gate_w).sum(-1, keepdims=True))
    a = _A_ref(x, A_wqkv, A_wo)
    b = _B_ref(x, B_wqkv, B_w_phi, B_wo)
    return g * a + (1 - g) * b
```

```asm
; @launch grid=(256,1,1) block=(512,1,1) lds=163840
.amdgcn_target "amdgcn-amd-amdhsa--gfx950"
.text
.globl gated_mix__mha_block__linear_kernel_hedgehog__prompt_kernel
.p2align 8
.type gated_mix__mha_block__linear_kernel_hedgehog__prompt_kernel,@function
gated_mix__mha_block__linear_kernel_hedgehog__prompt_kernel:
    s_cmp_ge_u32 s2, 256
    s_cbranch_scc1 L_end
    s_load_dwordx8 s[4:11], s[0:1], 0
    s_load_dwordx8 s[12:19], s[0:1], 32
    s_load_dwordx4 s[20:23], s[0:1], 64
    s_load_dwordx2 s[24:25], s[0:1], 80
    s_cmp_lt_u32 s2, 16
    s_cbranch_scc0 L_nocpf
    s_getpc_b64 s[60:61]
L_pcbase:
    s_mov_b32 s62, L_codeend-L_pcbase
    s_mov_b32 s63, 0x20000
    v_lshlrev_b32 v8, 7, v0
    buffer_load_dword v7, v8, s[60:63], 0 offen
L_nocpf:
    v_lshrrev_b32 v1, 6, v0
    s_and_b32 s50, s2, 7
    v_readfirstlane_b32 s3, v1
    s_lshr_b32 s47, s2, 3
    s_lshr_b32 s40, s50, 2
    s_lshl_b32 s40, s40, 3
    s_lshr_b32 s44, s47, 2
    s_add_u32 s40, s40, s44
    s_and_b32 s41, s50, 3
    s_lshl_b32 s41, s41, 1
    s_and_b32 s52, s47, 3
    s_and_b32 s51, s47, 1
    s_add_u32 s41, s41, s51
    s_lshr_b32 s42, s52, 1
    s_lshl_b32 s39, s42, 3
    s_add_u32 s39, s39, s41
    s_lshl_b32 s39, s39, 4
    s_add_u32 s39, s39, s40
    s_lshl_b32 s45, s50, 2
    s_add_u32 s43, s45, s52
    s_lshr_b32 s51, s47, 3
    s_add_u32 s45, s45, s51
    s_and_b32 s46, s47, 7
    s_and_b32 s36, s3, 3
    s_mul_i32 s38, s43, 180224
    v_and_b32 v1, 63, v0
    v_lshlrev_b32 v2, 4, v1
    s_cmp_lt_u32 s3, 4
    s_cbranch_scc1 L_compute
    s_min_u32 s54, s36, 1
    s_add_u32 s54, s54, 1
    s_mul_i32 s55, s54, 1280
    s_mul_i32 s56, s54, 160
    s_lshr_b32 s57, s36, 1
    s_mul_i32 s58, s57, 160
    s_lshl_b32 s59, s57, 8
    s_cmp_eq_u32 s42, 0
    s_cselect_b32 s58, s55, s58
    s_cselect_b32 s59, s55, s59
    s_cselect_b32 s56, 160, s56
    s_and_b32 s54, s41, 6
    s_mul_i32 s54, s54, s56
    s_add_u32 s59, s59, s54
    s_and_b32 s59, s59, 0xffffff80
    s_lshl_b32 s54, s44, 1
    s_and_b32 s51, s47, 1
    s_add_u32 s54, s54, s51
    s_mul_i32 s65, s54, 122880
    s_add_u32 s65, s65, s59
    s_add_u32 s65, s65, 491520
    s_mul_i32 s54, s54, 30720
    s_add_u32 s59, s59, s54
    s_movk_i32 s57, 3840
    v_min_u32 v8, 47, v1
    v_mul_u32_u24 v9, 86, v8
    v_lshrrev_b32 v9, 8, v9
    v_mul_u32_u24 v10, 3, v9
    v_sub_u32 v10, v8, v10
    v_lshlrev_b32 v10, 7, v10
    v_mad_u32_u24 v24, v9, s57, v10
    s_mul_i32 s60, s40, 163840
    s_mul_i32 s61, s52, 40960
    s_add_u32 s61, s61, s60
    v_and_b32 v8, 31, v1
    v_mul_u32_u24 v9, 1280, v8
    v_lshrrev_b32 v8, 5, v1
    v_lshl_add_u32 v8, v8, 7, v9
    s_cmp_eq_u32 s3, 7
    s_cselect_b64 vcc, -1, 0
    s_cselect_b32 s59, s61, s59
    s_cselect_b32 s34, 2621440, s57
    s_max_u32 s34, s34, 2457600
    s_or_b64 s[62:63], vcc, 16777215
    v_cndmask_b32 v25, v24, v8, vcc
    s_add_u32 s54, s36, s42
    s_cmp_ge_u32 s54, 2
    s_mov_b32 s35, 0x20000
    s_waitcnt lgkmcnt(0)
    s_cselect_b64 s[32:33], s[6:7], s[12:13]
    s_cmp_eq_u32 s3, 7
    s_cselect_b64 s[32:33], s[4:5], s[32:33]
    s_mov_b64 exec, s[62:63]
    buffer_load_dword v71, v25, s[32:35], s59 offen
    s_mov_b64 exec, -1
    s_cbranch_scc1 L_xload
    s_cmp_eq_u32 s42, 0
    s_cselect_b32 s66, 7, 7
    s_cmp_eq_u32 s54, 1
    s_cselect_b32 s66, s66, 10
    s_lshl_b32 s47, s44, 2
    s_lshr_b32 s47, 1715741184, s47
    s_and_b32 s47, s47, 15
    s_mov_b32 s28, s24
    s_mov_b32 s29, s25
    s_mov_b32 s30, 33554432
    s_mov_b32 s31, 0x20000
    s_mov_b64 s[0:1], s[4:5]
    s_mov_b32 s24, s65
    s_mov_b32 s25, s66
    s_mov_b32 s48, 0
    s_mov_b32 s49, 0
    s_mul_i32 s54, s41, s56
    s_add_u32 s40, s58, s54
    s_mul_i32 s41, s36, 10240
    v_add_u32 v8, 0, v1
    v_mul_u32_u24 v9, 6554, v8
    v_lshrrev_b32 v9, 16, v9
    v_mul_u32_u24 v10, 10, v9
    v_sub_u32 v10, v8, v10
    v_and_b32 v11, 3, v9
    v_bfe_u32 v12, v9, 2, 2
    v_lshl_add_u32 v11, v12, 3, v11
    v_bfe_u32 v12, v9, 4, 1
    v_lshl_add_u32 v11, v12, 2, v11
    v_lshlrev_b32 v10, 4, v10
    v_mad_u32_u24 v16, v11, s57, v10
    v_add_u32 v8, 64, v1
    v_mul_u32_u24 v9, 6554, v8
    v_lshrrev_b32 v9, 16, v9
    v_mul_u32_u24 v10, 10, v9
    v_sub_u32 v10, v8, v10
    v_and_b32 v11, 3, v9
    v_bfe_u32 v12, v9, 2, 2
    v_lshl_add_u32 v11, v12, 3, v11
    v_bfe_u32 v12, v9, 4, 1
    v_lshl_add_u32 v11, v12, 2, v11
    v_lshlrev_b32 v10, 4, v10
    v_mad_u32_u24 v17, v11, s57, v10
    v_add_u32 v8, 128, v1
    v_mul_u32_u24 v9, 6554, v8
    v_lshrrev_b32 v9, 16, v9
    v_mul_u32_u24 v10, 10, v9
    v_sub_u32 v10, v8, v10
    v_and_b32 v11, 3, v9
    v_bfe_u32 v12, v9, 2, 2
    v_lshl_add_u32 v11, v12, 3, v11
    v_bfe_u32 v12, v9, 4, 1
    v_lshl_add_u32 v11, v12, 2, v11
    v_lshlrev_b32 v10, 4, v10
    v_mad_u32_u24 v18, v11, s57, v10
    v_add_u32 v8, 192, v1
    v_mul_u32_u24 v9, 6554, v8
    v_lshrrev_b32 v9, 16, v9
    v_mul_u32_u24 v10, 10, v9
    v_sub_u32 v10, v8, v10
    v_and_b32 v11, 3, v9
    v_bfe_u32 v12, v9, 2, 2
    v_lshl_add_u32 v11, v12, 3, v11
    v_bfe_u32 v12, v9, 4, 1
    v_lshl_add_u32 v11, v12, 2, v11
    v_lshlrev_b32 v10, 4, v10
    v_mad_u32_u24 v19, v11, s57, v10
    v_add_u32 v8, 256, v1
    v_mul_u32_u24 v9, 6554, v8
    v_lshrrev_b32 v9, 16, v9
    v_mul_u32_u24 v10, 10, v9
    v_sub_u32 v10, v8, v10
    v_and_b32 v11, 3, v9
    v_bfe_u32 v12, v9, 2, 2
    v_lshl_add_u32 v11, v12, 3, v11
    v_bfe_u32 v12, v9, 4, 1
    v_lshl_add_u32 v11, v12, 2, v11
    v_lshlrev_b32 v10, 4, v10
    v_mad_u32_u24 v20, v11, s57, v10
    s_getpc_b64 s[26:27]
L_wl_pc:
    s_add_u32 s26, s26, L_wl_r0-L_wl_pc
    s_addc_u32 s27, s27, 0
L_wl_issue:
    s_cmp_eq_u32 s48, s47
    s_cbranch_scc0 L_wl_nopf
    buffer_load_dword v71, v24, s[32:35], s24 offen
    s_add_u32 s24, s24, 61440
    buffer_load_dword v71, v24, s[32:35], s24 offen
L_wl_nopf:
    s_add_u32 m0, s49, s41
    s_nop 0
    buffer_load_dwordx4 v16, s[32:35], s40 offen lds
    s_add_u32 m0, m0, 1024
    s_nop 0
    buffer_load_dwordx4 v17, s[32:35], s40 offen lds
    s_add_u32 m0, m0, 1024
    s_nop 0
    buffer_load_dwordx4 v18, s[32:35], s40 offen lds
    s_add_u32 m0, m0, 1024
    s_nop 0
    buffer_load_dwordx4 v19, s[32:35], s40 offen lds
    s_add_u32 m0, m0, 1024
    s_nop 0
    buffer_load_dwordx4 v20, s[32:35], s40 offen lds
    s_add_u32 m0, m0, 1024
    s_add_u32 s40, s40, 122880
    buffer_load_dwordx4 v16, s[32:35], s40 offen lds
    s_add_u32 m0, m0, 1024
    s_nop 0
    buffer_load_dwordx4 v17, s[32:35], s40 offen lds
    s_add_u32 m0, m0, 1024
    s_nop 0
    buffer_load_dwordx4 v18, s[32:35], s40 offen lds
    s_add_u32 m0, m0, 1024
    s_nop 0
    buffer_load_dwordx4 v19, s[32:35], s40 offen lds
    s_add_u32 m0, m0, 1024
    s_nop 0
    buffer_load_dwordx4 v20, s[32:35], s40 offen lds
    s_add_u32 s40, s40, 122880
    s_add_u32 s49, s49, 47104
    s_cmp_eq_u32 s49, 141312
    s_cselect_b32 s49, 0, s49
    s_add_u32 s48, s48, 1
    s_setpc_b64 s[26:27]
L_wl_r0:
    s_call_b64 s[26:27], L_wl_issue
    s_waitcnt vmcnt(10)
    s_barrier
L_wl_loop:
    s_call_b64 s[26:27], L_wl_issue
    s_sub_u32 s50, s48, s47
    s_waitcnt vmcnt(12)
    s_cmp_eq_u32 s50, 1
    s_cbranch_scc1 L_wl_w
    s_waitcnt vmcnt(10)
L_wl_w:
    s_barrier
    s_cmp_lt_u32 s48, s25
    s_cbranch_scc1 L_wl_loop
    s_cmp_eq_u32 s25, 10
    s_cbranch_scc1 L_adone
    v_lshlrev_b32 v9, 21, v1
    buffer_load_dword v71, v9, s[28:31], 0 offen
    s_mov_b32 s60, s20
    s_mov_b32 s61, s21
    s_mov_b32 s62, 2621440
    s_mov_b32 s63, 0x20000
    buffer_load_dword v71, v9, s[60:63], 0 offen
    s_mov_b32 s60, s8
    s_mov_b32 s61, s9
    s_mov_b32 s62, 819200
    s_mov_b32 s63, 0x20000
    buffer_load_dword v71, v9, s[60:63], 0 offen
    s_mov_b32 s60, s16
    s_mov_b32 s61, s17
    s_mov_b32 s62, 819200
    s_mov_b32 s63, 0x20000
    buffer_load_dword v71, v9, s[60:63], 0 offen
    s_setprio 3
    s_waitcnt vmcnt(0)
    s_barrier
    s_call_b64 s[26:27], L_setup
    s_barrier
    s_call_b64 s[26:27], L_lsetup
    s_barrier
    s_call_b64 s[26:27], L_wl_issue
    s_call_b64 s[26:27], L_wl_issue
    s_call_b64 s[26:27], L_wl_issue
    s_barrier
L_bt2:
    s_branch L_nonced
L_xload:
    s_mul_i32 s58, s40, 163840
    v_mov_b32 v24, v25
    s_lshr_b32 s65, s44, 1
    s_lshl_b32 s65, s65, 8
    s_and_b32 s66, s44, 1
    s_mul_i32 s66, s66, 655360
    s_add_u32 s65, s65, s66
    s_add_u32 s65, s65, 256
    s_cmp_lt_u32 s41, 4
    s_cselect_b32 s67, 3, 3
    s_sub_u32 s53, 8, s67
    s_cmp_eq_u32 s42, 0
    s_cselect_b32 s53, s67, s53
    s_and_b32 s66, s52, 1
    s_lshl_b32 s66, s66, 3
    s_mul_i32 s67, s42, s67
    s_add_u32 s66, s66, s67
    s_mul_i32 s66, s66, 40960
    s_add_u32 s65, s65, s66
    s_and_b32 s66, s40, 8
    s_mul_i32 s66, s66, 163840
    s_add_u32 s65, s65, s66
    s_mov_b32 s66, 10
    s_lshl_b32 s47, s44, 2
    s_lshr_b32 s47, 1715741184, s47
    s_and_b32 s47, s47, 15
    s_mov_b32 s28, s24
    s_mov_b32 s29, s25
    s_mov_b32 s30, 33554432
    s_mov_b32 s31, 0x20000
    s_mov_b64 s[0:1], s[4:5]
    s_mov_b32 s24, s65
    s_mov_b32 s25, s66
    s_mov_b32 s48, 0
    s_mov_b32 s49, 0
    s_mul_i32 s54, s41, 3200
    s_add_u32 s72, s14, s54
    s_addc_u32 s73, s15, 0
    s_mov_b32 s74, 3200
    s_mov_b32 s75, 0x20000
    v_lshrrev_b32 v9, 3, v1
    v_and_b32 v10, 7, v1
    v_xor_b32 v10, v10, v9
    v_lshlrev_b32 v10, 4, v10
    s_movk_i32 s57, 1280
    v_mad_u32_u24 v16, v9, s57, v10
    s_mov_b32 s40, s58
    s_getpc_b64 s[26:27]
L_xl_pc:
    s_add_u32 s26, s26, L_xl_r0-L_xl_pc
    s_addc_u32 s27, s27, 0
L_xl_issue:
    s_cmp_eq_u32 s48, s47
    s_cbranch_scc0 L_xl_nopf
    buffer_load_dword v71, v24, s[32:35], s24 offen
    s_add_u32 s24, s24, 40960
    buffer_load_dword v71, v24, s[32:35], s24 offen
    s_add_u32 s24, s24, 40960
    buffer_load_dword v71, v24, s[32:35], s24 offen
    s_add_u32 s24, s24, 40960
    s_cmp_eq_u32 s53, 3
    s_cselect_b32 s24, 1073741824, s24
    buffer_load_dword v71, v24, s[32:35], s24 offen
    s_add_u32 s24, s24, 40960
    s_cmp_eq_u32 s53, 4
    s_cselect_b32 s24, 1073741824, s24
    buffer_load_dword v71, v24, s[32:35], s24 offen
L_xl_nopf:
    s_add_u32 m0, s49, 30720
    s_mov_b32 s41, s40
    buffer_load_dwordx4 v16, s[32:35], s41 offen lds
    s_add_u32 m0, m0, 1024
    s_add_u32 s41, s41, 10240
    buffer_load_dwordx4 v16, s[32:35], s41 offen lds
    s_add_u32 m0, m0, 1024
    s_add_u32 s41, s41, 10240
    buffer_load_dwordx4 v16, s[32:35], s41 offen lds
    s_add_u32 m0, m0, 1024
    s_add_u32 s41, s41, 10240
    buffer_load_dwordx4 v16, s[32:35], s41 offen lds
    s_add_u32 m0, m0, 1024
    s_add_u32 s41, s41, 10240
    buffer_load_dwordx4 v16, s[32:35], s41 offen lds
    s_add_u32 m0, m0, 1024
    s_add_u32 s41, s41, 10240
    buffer_load_dwordx4 v16, s[32:35], s41 offen lds
    s_add_u32 m0, m0, 1024
    s_add_u32 s41, s41, 10240
    buffer_load_dwordx4 v16, s[32:35], s41 offen lds
    s_add_u32 m0, m0, 1024
    s_add_u32 s41, s41, 10240
    buffer_load_dwordx4 v16, s[32:35], s41 offen lds
    s_add_u32 m0, m0, 1024
    s_add_u32 s41, s41, 10240
    buffer_load_dwordx4 v16, s[32:35], s41 offen lds
    s_add_u32 m0, m0, 1024
    s_add_u32 s41, s41, 10240
    buffer_load_dwordx4 v16, s[32:35], s41 offen lds
    s_add_u32 m0, m0, 1024
    s_add_u32 s41, s41, 10240
    buffer_load_dwordx4 v16, s[32:35], s41 offen lds
    s_add_u32 m0, m0, 1024
    s_add_u32 s41, s41, 10240
    buffer_load_dwordx4 v16, s[32:35], s41 offen lds
    s_add_u32 m0, m0, 1024
    s_add_u32 s41, s41, 10240
    buffer_load_dwordx4 v16, s[32:35], s41 offen lds
    s_add_u32 m0, m0, 1024
    s_add_u32 s41, s41, 10240
    buffer_load_dwordx4 v16, s[32:35], s41 offen lds
    s_add_u32 m0, m0, 1024
    s_add_u32 s41, s41, 10240
    buffer_load_dwordx4 v16, s[32:35], s41 offen lds
    s_add_u32 m0, m0, 1024
    s_add_u32 s41, s41, 10240
    buffer_load_dwordx4 v16, s[32:35], s41 offen lds
    s_add_u32 s40, s40, 128
    s_add_u32 s49, s49, 47104
    s_cmp_eq_u32 s49, 141312
    s_cselect_b32 s49, 0, s49
    s_add_u32 s48, s48, 1
    s_setpc_b64 s[26:27]
L_xl_r0:
    s_call_b64 s[26:27], L_xl_issue
    s_waitcnt vmcnt(16)
    s_barrier
    s_mov_b32 m0, 141312
    s_nop 0
    buffer_load_dwordx4 v2, s[72:75], 0 offen offset:0 lds
    buffer_load_dwordx4 v2, s[72:75], 0 offen offset:1024 lds
    buffer_load_dwordx4 v2, s[72:75], 0 offen offset:2048 lds
    buffer_load_dwordx4 v2, s[72:75], 0 offen offset:3072 lds
    s_mov_b32 s60, s22
    s_mov_b32 s61, s23
    s_mov_b32 s62, 256
    s_mov_b32 s63, 0x20000
    v_mov_b32 v8, 0
    buffer_load_dwordx2 v[36:37], v8, s[60:63], 0 offen sc1
L_xl_loop:
    s_call_b64 s[26:27], L_xl_issue
    s_sub_u32 s50, s48, s47
    s_waitcnt vmcnt(21)
    s_cmp_eq_u32 s50, 1
    s_cbranch_scc1 L_xl_w
    s_waitcnt vmcnt(16)
L_xl_w:
    s_barrier
    s_cmp_lt_u32 s48, s25
    s_cbranch_scc1 L_xl_loop
L_adone:
    s_setprio 3
    s_call_b64 s[26:27], L_setup
    s_waitcnt vmcnt(0)
    s_barrier
    s_call_b64 s[26:27], L_lsetup
    s_cmp_eq_u32 s3, 7
    s_cbranch_scc0 L_nonced
    s_mov_b32 s32, s22
    s_mov_b32 s33, s23
    s_mov_b32 s34, 256
    s_mov_b32 s35, 0x20000
    v_mov_b32 v16, 0
    s_mov_b32 s51, 400000
    s_branch L_noncew
L_nonce:
    buffer_load_dwordx2 v[36:37], v16, s[32:35], 0 offen sc1
L_noncew:
    s_waitcnt vmcnt(0)
    v_readfirstlane_b32 s48, v36
    v_readfirstlane_b32 s49, v37
    s_sub_u32 s51, s51, 1
    s_cbranch_scc1 L_nonced
    s_cmp_eq_u32 s48, 0
    s_cbranch_scc1 L_nonce
L_nonced:
    s_bitcmp0_b32 s39, 7
    s_cbranch_scc1 L_lphi
    s_waitcnt vmcnt(0)
    s_barrier
    s_barrier
    s_cmp_eq_u32 s3, 7
    s_cbranch_scc0 L_nopub1
    s_lshl_b32 s50, s39, 7
    s_add_u32 s50, s50, 29425664
    v_mov_b32 v24, s48
    v_mov_b32 v25, s49
    v_mov_b32 v26, 0
    s_mov_b64 exec, 1
    buffer_store_dwordx2 v[24:25], v26, s[28:31], s50 offen sc1
    s_mov_b64 exec, -1
    v_mov_b32 v26, 163832
    ds_write_b64 v26, v[24:25]
L_nopub1:
    s_mov_b32 s60, s0
    s_mov_b32 s61, s1
    s_mov_b32 s62, 2621440
    s_mov_b32 s63, 0x20000
    s_mov_b32 s56, s18
    s_mov_b32 s57, s19
    s_mov_b32 s58, 1280
    s_mov_b32 s59, 0x20000
    s_and_b32 s53, s39, 15
    s_lshl_b32 s53, s53, 4
    s_lshr_b32 s50, s39, 4
    s_add_u32 s53, s53, s50
    s_lshl_b32 s53, s53, 2
    s_add_u32 s53, s53, s36
    s_mul_i32 s50, s53, 2560
    v_lshlrev_b32 v9, 2, v1
    buffer_load_dword v72, v9, s[60:63], s50 offen offset:0
    buffer_load_dword v73, v9, s[60:63], s50 offen offset:256
    buffer_load_dword v74, v9, s[60:63], s50 offen offset:512
    buffer_load_dword v75, v9, s[60:63], s50 offen offset:768
    buffer_load_dword v76, v9, s[60:63], s50 offen offset:1024
    buffer_load_dword v77, v9, s[60:63], s50 offen offset:1280
    buffer_load_dword v78, v9, s[60:63], s50 offen offset:1536
    buffer_load_dword v79, v9, s[60:63], s50 offen offset:1792
    buffer_load_dword v80, v9, s[60:63], s50 offen offset:2048
    buffer_load_dword v81, v9, s[60:63], s50 offen offset:2304
    buffer_load_dword v82, v9, s[56:59], 0 offen offset:0
    buffer_load_dword v83, v9, s[56:59], 0 offen offset:256
    buffer_load_dword v84, v9, s[56:59], 0 offen offset:512
    buffer_load_dword v85, v9, s[56:59], 0 offen offset:768
    buffer_load_dword v86, v9, s[56:59], 0 offen offset:1024
    s_lshl_b32 s53, s53, 7
    s_add_u32 s53, s53, 29491200
    s_cmp_eq_u32 s3, 7
    s_cselect_b64 exec, -1, 0
    s_mov_b32 s50, 29425664
    buffer_load_dwordx2 v[22:23], v70, s[28:31], s50 offen sc1
    s_mov_b64 exec, -1
L_ldone:
    v_mov_b32 v112, v104
    v_mov_b32 v113, v105
    v_mov_b32 v114, v106
    v_mov_b32 v8, 163824
    v_mov_b32 v26, 163816
    s_cmp_eq_u32 s3, 7
    s_cbranch_scc0 L_lw
    s_mov_b32 s56, 50529027
    s_mov_b32 s57, -1
    s_mov_b32 s50, 29425664
    s_mov_b32 s51, 400000
    s_branch L_pollw1
L_poll1:
    buffer_load_dwordx2 v[22:23], v70, s[28:31], s50 offen sc1
L_pollw1:
    s_waitcnt vmcnt(0)
    v_cmp_ne_u64 vcc, s[48:49], v[22:23]
    s_sub_u32 s51, s51, 1
    s_cbranch_scc1 L_polled1
    s_and_b64 s[58:59], vcc, s[56:57]
    s_cbranch_scc0 L_polled1
    s_mov_b64 exec, vcc
    s_sleep 1
    s_branch L_poll1
L_polled1:
    s_mov_b64 exec, -1
    s_mov_b64 s[56:57], vcc
    v_mov_b32 v24, 1
    ds_write_b32 v26, v24
    s_branch L_lwd
L_lw:
    s_sleep 1
    ds_read_b32 v24, v26
    s_waitcnt lgkmcnt(0)
    v_cmp_eq_u32 vcc, 0, v24
    s_cbranch_vccnz L_lw
L_lwd:
    s_add_u32 m0, s55, 147456
    s_nop 0
    buffer_load_dwordx4 v2, s[28:31], s54 offen offset:0 sc1 lds
    buffer_load_dwordx4 v2, s[28:31], s54 offen offset:1024 sc1 lds
    s_mov_b32 exec_hi, 0
    buffer_load_dwordx4 v2, s[28:31], s54 offen offset:2048 sc1 lds
    s_mov_b32 exec_hi, -1
    s_lshl_b32 s50, s36, 10
    s_add_u32 m0, s50, 0
    s_add_u32 s51, s38, 6291456
    s_add_u32 s51, s51, s50
    buffer_load_dwordx4 v2, s[28:31], s51 offen sc1 lds
    s_add_u32 m0, m0, 4096
    s_add_u32 s51, s51, 4096
    buffer_load_dwordx4 v2, s[28:31], s51 offen sc1 lds
    s_add_u32 m0, m0, 4096
    s_add_u32 s51, s51, 4096
    buffer_load_dwordx4 v2, s[28:31], s51 offen sc1 lds
    s_add_u32 m0, m0, 4096
    s_add_u32 s51, s51, 4096
    buffer_load_dwordx4 v2, s[28:31], s51 offen sc1 lds
    s_add_u32 m0, m0, 4096
    s_add_u32 s51, s51, 4096
    buffer_load_dwordx4 v2, s[28:31], s51 offen sc1 lds
    s_add_u32 m0, m0, 4096
    s_add_u32 s51, s51, 4096
    buffer_load_dwordx4 v2, s[28:31], s51 offen sc1 lds
    s_mov_b32 s54, s51
    s_setprio 0
    s_waitcnt vmcnt(9)
    v_mov_b32 v16, 0
    v_mov_b32 v238, 0
    v_mov_b32 v239, 0
    v_dot2_f32_bf16 v238, v72, v82, v238
    v_dot2_f32_bf16 v239, v77, v82, v239
    v_dot2_f32_bf16 v238, v73, v83, v238
    v_dot2_f32_bf16 v239, v78, v83, v239
    v_dot2_f32_bf16 v238, v74, v84, v238
    v_dot2_f32_bf16 v239, v79, v84, v239
    v_dot2_f32_bf16 v238, v75, v85, v238
    v_dot2_f32_bf16 v239, v80, v85, v239
    v_dot2_f32_bf16 v238, v76, v86, v238
    v_dot2_f32_bf16 v239, v81, v86, v239
    s_nop 2
    v_add_f32_dpp v238, v238, v238 row_shr:1 row_mask:0xf bank_mask:0xf bound_ctrl:0
    v_add_f32_dpp v239, v239, v239 row_shr:1 row_mask:0xf bank_mask:0xf bound_ctrl:0
    s_nop 0
    v_add_f32_dpp v238, v238, v238 row_shr:2 row_mask:0xf bank_mask:0xf bound_ctrl:0
    v_add_f32_dpp v239, v239, v239 row_shr:2 row_mask:0xf bank_mask:0xf bound_ctrl:0
    s_nop 0
    v_add_f32_dpp v238, v238, v238 row_shr:4 row_mask:0xf bank_mask:0xf bound_ctrl:0
    v_add_f32_dpp v239, v239, v239 row_shr:4 row_mask:0xf bank_mask:0xf bound_ctrl:0
    s_nop 0
    v_add_f32_dpp v238, v238, v238 row_shr:8 row_mask:0xf bank_mask:0xf bound_ctrl:0
    v_add_f32_dpp v239, v239, v239 row_shr:8 row_mask:0xf bank_mask:0xf bound_ctrl:0
    s_nop 0
    v_add_f32_dpp v238, v238, v238 row_bcast:15 row_mask:0xa bank_mask:0xf
    v_add_f32_dpp v239, v239, v239 row_bcast:15 row_mask:0xa bank_mask:0xf
    s_nop 0
    v_add_f32_dpp v238, v238, v238 row_bcast:31 row_mask:0xc bank_mask:0xf
    v_add_f32_dpp v239, v239, v239 row_bcast:31 row_mask:0xc bank_mask:0xf
    s_nop 0
    v_mul_f32 v238, 3216550459, v238
    v_mul_f32 v239, 3216550459, v239
    v_exp_f32 v238, v238
    v_exp_f32 v239, v239
    s_nop 0
    v_add_f32 v238, 1.0, v238
    v_add_f32 v239, 1.0, v239
    v_rcp_f32 v238, v238
    v_rcp_f32 v239, v239
    v_cmp_gt_u32 vcc, 16, v1
    v_mov_b32 v17, 1073741824
    v_readlane_b32 s50, v238, 63
    v_readlane_b32 s51, v239, 63
    v_cndmask_b32 v246, v17, v253, vcc
    s_nop 0
    v_mov_b32 v238, s50
    v_mov_b32 v239, s51
    s_setprio 3
    s_cmp_eq_u32 s3, 7
    s_cselect_b64 s[56:57], s[56:57], 0
    s_cmp_eq_u64 s[56:57], 0
    s_cbranch_scc1 L_es
    s_mov_b64 exec, s[56:57]
    s_mov_b32 s50, 29425664
    s_mov_b32 s51, 400000
L_poll2:
    buffer_load_dwordx2 v[22:23], v70, s[28:31], s50 offen sc1
L_pollw2:
    s_waitcnt vmcnt(0)
    v_cmp_ne_u64 vcc, s[48:49], v[22:23]
    s_sub_u32 s51, s51, 1
    s_cbranch_scc1 L_polled2
    s_cbranch_vccz L_polled2
    s_mov_b64 exec, vcc
    s_sleep 1
    s_branch L_poll2
L_polled2:
    s_mov_b64 exec, -1
L_es:
    s_add_u32 m0, m0, 4096
    s_add_u32 s54, s54, 4096
    buffer_load_dwordx4 v2, s[28:31], s54 offen sc1 lds
    s_add_u32 m0, m0, 4096
    s_add_u32 s54, s54, 4096
    buffer_load_dwordx4 v2, s[28:31], s54 offen sc1 lds
    s_add_u32 m0, m0, 4096
    s_add_u32 s54, s54, 4096
    buffer_load_dwordx4 v2, s[28:31], s54 offen sc1 lds
    s_add_u32 m0, m0, 4096
    s_add_u32 s54, s54, 4096
    buffer_load_dwordx4 v2, s[28:31], s54 offen sc1 lds
    s_add_u32 m0, m0, 4096
    s_add_u32 s54, s54, 4096
    buffer_load_dwordx4 v2, s[28:31], s54 offen sc1 lds
    s_waitcnt vmcnt(5) lgkmcnt(0)
    s_barrier
    buffer_load_ushort v206, v112, s[4:7], s42 offen offset:0
    buffer_load_ushort v207, v112, s[4:7], s42 offen offset:1280
    buffer_load_ushort v208, v112, s[4:7], s42 offen offset:2560
    buffer_load_ushort v209, v112, s[4:7], s42 offen offset:3840
    s_add_u32 s42, s42, s10
    buffer_load_ushort v210, v112, s[4:7], s42 offen offset:0
    buffer_load_ushort v211, v112, s[4:7], s42 offen offset:1280
    buffer_load_ushort v212, v112, s[4:7], s42 offen offset:2560
    buffer_load_ushort v213, v112, s[4:7], s42 offen offset:3840
    buffer_load_ushort v214, v113, s[12:15], s52 offen offset:0
    buffer_load_ushort v215, v113, s[12:15], s52 offen offset:1280
    buffer_load_ushort v216, v113, s[12:15], s52 offen offset:2560
    buffer_load_ushort v217, v113, s[12:15], s52 offen offset:3840
    s_add_u32 s52, s52, s11
    buffer_load_ushort v218, v113, s[12:15], s52 offen offset:0
    buffer_load_ushort v219, v113, s[12:15], s52 offen offset:1280
    buffer_load_ushort v220, v113, s[12:15], s52 offen offset:2560
    buffer_load_ushort v221, v113, s[12:15], s52 offen offset:3840
    s_branch L_p2b
L_lsetup:
    s_lshr_b32 s54, s43, 3
    s_lshl_b32 s54, s54, 4
    s_add_u32 s55, s54, 192
    v_add_u32 v33, s55, v3
    s_lshr_b32 s55, s43, 2
    s_lshl_b32 s55, s55, 4
    v_add_u32 v34, s55, v3
    s_lshl_b32 s55, s44, 1
    s_add_u32 s54, s54, s55
    s_add_u32 s54, s54, 128
    v_and_b32 v35, 1, v1
    v_add_u32 v35, s54, v35
    v_cmp_gt_u32 vcc, 16, v1
    s_nop 1
    v_cndmask_b32 v33, v34, v33, vcc
    v_cmp_gt_u32 vcc, 32, v1
    s_nop 1
    v_cndmask_b32 v33, v35, v33, vcc
    v_lshlrev_b32 v70, 7, v33
    s_lshl_b32 s54, s44, 2
    s_add_u32 s54, s54, s36
    s_mul_i32 s54, s54, 5632
    s_add_u32 s54, s54, s38
    s_mul_i32 s55, s36, 3072
    v_lshrrev_b32 v28, 1, v4
    v_mul_u32_u24 v28, 20, v28
    v_and_b32 v29, 1, v4
    v_lshl_add_u32 v28, v29, 3, v28
    v_mul_u32_u24 v28, 1280, v28
    v_lshl_add_u32 v28, v3, 1, v28
    v_mul_u32_u24 v29, 25600, v4
    v_lshl_add_u32 v29, v3, 1, v29
    s_lshl_b32 s57, s2, 2
    s_add_u32 s57, s57, s36
    s_add_u32 s42, s57, 0
    s_min_u32 s42, s42, 1599
    s_mul_i32 s58, s42, 5243
    s_lshr_b32 s58, s58, 20
    s_mul_i32 s59, s58, 200
    s_sub_u32 s42, s42, s59
    s_mul_i32 s59, s42, 205
    s_lshr_b32 s59, s59, 10
    s_mul_i32 s50, s59, 5
    s_sub_u32 s42, s42, s50
    s_cmp_ge_u32 s42, 3
    s_cselect_b32 s50, 40, 0
    s_lshl_b32 s51, s42, 3
    s_add_u32 s50, s50, s51
    s_and_b32 s51, s58, 1
    s_lshl_b32 s51, s51, 5
    s_add_u32 s50, s50, s51
    s_lshl_b32 s51, s51, 2
    s_sub_u32 s51, 128, s51
    s_cmp_eq_u32 s42, 2
    s_cselect_b32 s42, s51, s50
    s_cselect_b32 s50, 0, 24
    v_lshlrev_b32 v30, 1, v3
    v_and_b32 v32, s50, v30
    s_mul_i32 s58, s58, 160
    s_add_u32 s42, s42, s58
    s_cmp_ge_u32 s59, 20
    s_cselect_b64 s[4:5], s[16:17], s[8:9]
    s_cselect_b32 s58, 20, 0
    s_sub_u32 s59, s59, s58
    s_mov_b32 s6, 819200
    s_mov_b32 s7, 0x20000
    s_cmp_ge_u32 s59, 10
    s_cselect_b32 s58, 10, 0
    s_sub_u32 s59, s59, s58
    s_mul_i32 s58, s58, 32
    s_mul_i32 s50, s59, 40
    s_mul_i32 s51, s59, 160
    s_sub_u32 s51, s51, 1264
    s_cmp_ge_u32 s59, 8
    s_cselect_b32 s50, s51, s50
    s_cselect_b64 vcc, -1, 0
    s_movk_i32 s10, 5120
    s_cselect_b32 s10, 102400, s10
    s_add_u32 s50, s50, s58
    s_mul_i32 s50, s50, 1280
    s_add_u32 s42, s42, s50
    v_cndmask_b32 v104, v28, v29, vcc
    v_add_u32 v104, v104, v32
    s_add_u32 s52, s57, 1024
    s_min_u32 s52, s52, 1599
    s_mul_i32 s58, s52, 5243
    s_lshr_b32 s58, s58, 20
    s_mul_i32 s59, s58, 200
    s_sub_u32 s52, s52, s59
    s_mul_i32 s59, s52, 205
    s_lshr_b32 s59, s59, 10
    s_mul_i32 s50, s59, 5
    s_sub_u32 s52, s52, s50
    s_cmp_ge_u32 s52, 3
    s_cselect_b32 s50, 40, 0
    s_lshl_b32 s51, s52, 3
    s_add_u32 s50, s50, s51
    s_and_b32 s51, s58, 1
    s_lshl_b32 s51, s51, 5
    s_add_u32 s50, s50, s51
    s_lshl_b32 s51, s51, 2
    s_sub_u32 s51, 128, s51
    s_cmp_eq_u32 s52, 2
    s_cselect_b32 s52, s51, s50
    s_cselect_b32 s50, 0, 24
    v_lshlrev_b32 v30, 1, v3
    v_and_b32 v31, s50, v30
    s_mul_i32 s58, s58, 160
    s_add_u32 s52, s52, s58
    s_cmp_ge_u32 s59, 20
    s_cselect_b64 s[12:13], s[16:17], s[8:9]
    s_cselect_b32 s58, 20, 0
    s_sub_u32 s59, s59, s58
    s_mov_b32 s14, 819200
    s_mov_b32 s15, 0x20000
    s_cmp_ge_u32 s59, 10
    s_cselect_b32 s58, 10, 0
    s_sub_u32 s59, s59, s58
    s_mul_i32 s58, s58, 32
    s_mul_i32 s50, s59, 40
    s_mul_i32 s51, s59, 160
    s_sub_u32 s51, s51, 1264
    s_cmp_ge_u32 s59, 8
    s_cselect_b32 s50, s51, s50
    s_cselect_b64 vcc, -1, 0
    s_movk_i32 s11, 5120
    s_cselect_b32 s11, 102400, s11
    s_add_u32 s50, s50, s58
    s_mul_i32 s50, s50, 1280
    s_add_u32 s52, s52, s50
    v_cndmask_b32 v105, v28, v29, vcc
    v_add_u32 v105, v105, v31
    s_lshl_b32 s75, s57, 10
    s_add_u32 s75, s75, 27262976
    s_mov_b32 s76, 0
    s_cmp_lt_u32 s57, 576
    s_cselect_b32 s77, 0, 1073741824
    v_or_b32 v106, s77, v2
    v_mov_b32 v241, 1073741824
    s_mul_i32 s50, s36, 3072
    s_add_u32 s50, s50, 147456
    s_lshr_b32 s51, s3, 2
    s_lshl_b32 s58, s51, 10
    s_add_u32 s58, s58, s50
    v_add_u32 v14, s58, v2
    s_lshl_b32 s37, s51, 1
    s_sub_u32 s37, 1, s37
    s_xor_b32 s51, s51, 1
    v_bfe_u32 v15, v1, 4, 1
    v_lshlrev_b32 v15, 3, v15
    v_lshl_add_u32 v15, v3, 4, v15
    v_xor_b32 v13, s51, v6
    v_lshl_add_u32 v15, v13, 8, v15
    v_add_u32 v15, s50, v15
    s_setpc_b64 s[26:27]
L_setup:
    v_and_b32 v3, 15, v1
    v_lshrrev_b32 v4, 4, v1
    v_and_b32 v5, 31, v1
    v_lshrrev_b32 v6, 5, v1
    v_bfe_u32 v8, v1, 3, 2
    v_and_b32 v9, 3, v1
    v_lshl_add_u32 v8, v8, 2, v9
    v_lshlrev_b32 v8, 4, v8
    v_bfe_u32 v9, v1, 2, 1
    v_lshl_add_u32 v10, v9, 8, v8
    s_lshr_b32 s52, s3, 2
    s_lshl_b32 s50, s52, 10
    v_lshl_add_u32 v10, v6, 9, v10
    v_add_u32 v247, s50, v10
    s_lshl_b32 s50, s52, 8
    v_lshl_add_u32 v10, v9, 3, v8
    v_add_u32 v248, s50, v10
    s_mov_b32 s60, 68160512
    s_mov_b32 s61, 134744084
    s_mov_b32 s62, 201590784
    s_mov_b32 s63, 336860176
    v_bfe_u32 v8, v1, 2, 3
    v_lshlrev_b32 v8, 3, v8
    v_lshrrev_b64 v[10:11], v8, s[60:61]
    v_lshrrev_b64 v[12:13], v8, s[62:63]
    v_and_b32 v10, 255, v10
    v_and_b32 v12, 255, v12
    v_and_b32 v9, 3, v1
    v_cmp_gt_u32 vcc, 20, v5
    v_mov_b32 v8, 0
    s_nop 0
    v_cndmask_b32 v9, v8, v9, vcc
    v_add_u32 v10, v10, v9
    v_add_u32 v12, v12, v9
    v_mul_u32_u24 v8, 384, v6
    v_lshl_add_u32 v10, v10, 4, v8
    s_mul_i32 s50, s52, 1536
    s_add_u32 s50, s50, 2560
    v_add_u32 v10, s50, v10
    v_mov_b32 v9, 1
    v_lshlrev_b32 v9, v5, v9
    v_and_b32 v9, 0xeef00000, v9
    v_cmp_ne_u32 vcc, 0, v9
    v_mov_b32 v9, 0x40000
    v_lshrrev_b32 v11, 4, v12
    v_cndmask_b32 v249, v10, v9, vcc
    v_mul_u32_u24 v11, 1536, v11
    v_and_b32 v12, 15, v12
    v_lshl_add_u32 v12, v12, 5, v11
    v_lshl_add_u32 v12, v6, 3, v12
    v_add_u32 v250, 159744, v12
    v_bfe_u32 v8, v1, 4, 1
    v_mul_u32_u24 v8, 40960, v8
    v_lshl_add_u32 v9, v3, 4, v8
    v_lshl_add_u32 v251, v6, 8, v9
    v_lshl_add_u32 v8, v3, 3, v8
    v_lshlrev_b32 v253, 3, v1
    v_mov_b32 v9, 1073741824
    v_cmp_gt_u32 vcc, 32, v1
    s_nop 1
    v_cndmask_b32 v252, v9, v8, vcc
    s_lshl_b32 s50, s45, 6
    s_lshl_b32 s51, s36, 4
    s_add_u32 s50, s50, s51
    v_add_u32 v8, s50, v3
    v_mul_u32_u24 v8, 1280, v8
    v_lshl_add_u32 v254, v4, 3, v8
    v_bfe_u32 v8, v1, 4, 1
    v_mul_u32_u24 v8, 1280, v8
    v_lshl_add_u32 v8, v3, 4, v8
    v_lshl_add_u32 v242, v6, 8, v8
    v_lshl_add_u32 v243, v6, 3, v8
    v_lshrrev_b32 v8, 1, v0
    v_max_u32 v8, 192, v8
    v_subrev_u32 v8, 192, v8
    v_mul_u32_u24 v8, 52, v8
    v_lshrrev_b32 v8, 10, v8
    v_mul_u32_u24 v8, 704, v8
    v_lshl_add_u32 v244, v0, 3, v8
    v_mov_b32 v245, v2
    v_mov_b32 v246, 1073741824
    v_mov_b32 v255, 0
    s_lshr_b32 s50, s43, 2
    s_lshl_b32 s50, s50, 4
    v_add_u32 v8, s50, v3
    s_lshl_b32 s51, s44, 1
    s_add_u32 s50, s50, s51
    s_add_u32 s50, s50, 128
    v_and_b32 v9, 1, v1
    v_add_u32 v9, s50, v9
    v_cmp_gt_u32 vcc, 48, v1
    s_lshl_b32 s50, s3, 5
    v_add_u32 v10, s50, v1
    v_cndmask_b32 v8, v9, v8, vcc
    v_cmp_gt_u32 vcc, 32, v1
    s_lshr_b32 s52, s3, 2
    s_lshl_b32 s74, s3, 10
    v_cndmask_b32 v8, v8, v10, vcc
    v_lshlrev_b32 v240, 7, v8
    s_lshl_b32 s50, s44, 3
    s_lshl_b32 s51, s36, 1
    s_add_u32 s50, s50, s51
    s_add_u32 s50, s50, s52
    s_lshl_b32 s69, s50, 11
    s_add_u32 s69, s69, 29491200
    s_mul_i32 s66, s50, 2560
    s_mul_i32 s51, s43, 163840
    s_add_u32 s66, s66, s51
    s_add_u32 s66, s66, 12582912
    s_mul_i32 s50, s50, 81920
    s_lshr_b32 s51, s43, 4
    s_mul_i32 s51, s51, 10240
    s_add_u32 s50, s50, s51
    s_add_u32 s50, s50, 20971520
    s_and_b32 s51, s43, 15
    s_lshl_b32 s64, s51, 9
    s_add_u32 s64, s64, s50
    s_lshl_b32 s65, s51, 7
    s_add_u32 s65, s65, s50
    s_add_u32 s65, s65, 8192
    s_mul_i32 s67, s43, 98304
    s_add_u32 s67, s67, 17825792
    s_lshl_b32 s50, s45, 2
    s_add_u32 s50, s50, s36
    s_mul_i32 s68, s50, 40960
    s_and_b32 s51, s46, 1
    s_xor_b32 s52, s52, s51
    s_mul_i32 s51, s52, 10240
    s_add_u32 s68, s68, s51
    s_add_u32 s68, s68, 20971520
    s_mul_i32 s70, s46, 204800
    s_add_u32 s70, s70, 27262976
    s_lshl_b32 s71, s2, 3
    s_add_u32 s71, s71, s3
    s_mul_i32 s71, s71, 2560
    s_add_u32 s71, s71, 20971520
    s_lshl_b32 s72, s39, 7
    s_add_u32 s72, s72, 29458432
    s_cmp_eq_u32 s3, 4
    s_cselect_b32 s73, 0, 1073741824
    s_mov_b32 s79, 0
    s_lshr_b32 s78, s3, 2
    s_setpc_b64 s[26:27]
L_compute:
    s_waitcnt lgkmcnt(0)
    s_mov_b32 s28, s24
    s_mov_b32 s29, s25
    s_mov_b32 s30, 33554432
    s_mov_b32 s31, 0x20000
    s_or_b32 s50, s2, s3
    s_cmp_eq_u32 s50, 0
    s_cbranch_scc0 L_nononce
    s_memrealtime s[50:51]
    s_mov_b32 s60, s22
    s_mov_b32 s61, s23
    s_mov_b32 s62, 256
    s_mov_b32 s63, 0x20000
    s_waitcnt lgkmcnt(0)
    s_or_b32 s50, s50, 1
    v_mov_b32 v8, s50
    v_mov_b32 v9, s51
    v_mov_b32 v10, 0
    s_mov_b64 exec, 1
    buffer_store_dwordx2 v[8:9], v10, s[60:63], 0 offen sc1
    s_mov_b64 exec, -1
L_nononce:
    s_sub_u32 s50, s2, 0
    s_cmp_lt_u32 s50, 8
    s_cbranch_scc0 L_notlb
    s_cmp_eq_u32 s3, 1
    s_cbranch_scc0 L_notlb
    v_lshlrev_b32 v16, 21, v1
    v_lshlrev_b32 v18, 21, v1
    v_lshlrev_b32 v17, 7, v1
    s_mov_b32 s60, s24
    s_mov_b32 s61, s25
    s_mov_b32 s62, 33554432
    s_mov_b32 s63, 0x20000
    buffer_load_dword v7, v16, s[60:63], 0 offen
    s_mov_b32 s60, s20
    s_mov_b32 s61, s21
    s_mov_b32 s62, 2621440
    s_mov_b32 s63, 0x20000
    buffer_load_dword v7, v18, s[60:63], 0 offen
    s_mov_b32 s60, s18
    s_mov_b32 s61, s19
    s_mov_b32 s62, 1280
    s_mov_b32 s63, 0x20000
    buffer_load_dword v7, v17, s[60:63], 0 offen
    s_mov_b32 s60, s8
    s_mov_b32 s61, s9
    s_mov_b32 s62, 819200
    s_mov_b32 s63, 0x20000
    buffer_load_dword v7, v18, s[60:63], 0 offen
    s_mov_b32 s60, s16
    s_mov_b32 s61, s17
    s_mov_b32 s62, 819200
    s_mov_b32 s63, 0x20000
    buffer_load_dword v7, v18, s[60:63], 0 offen
L_notlb:
    s_call_b64 s[26:27], L_setup
    v_lshrrev_b32 v9, 2, v1
    v_mul_u32_u24 v8, 160, v9
    v_and_b32 v9, 3, v1
    v_mul_u32_u24 v9, 40, v9
    v_add_u32 v8, v8, v9
    v_and_b32 v10, 7, v3
    s_lshl_b32 s50, s3, 5
    v_add_u32 v12, s50, v3
    v_lshlrev_b32 v12, 7, v12
    v_xor_b32 v10, v10, v4
    v_lshl_add_u32 v9, v10, 4, v12
    v_add_u32 v9, 30720, v9
    v_xor_b32 v10, 64, v9
    v_mov_b32 v14, 0
    v_mov_b32 v15, 0
    v_mov_b64 v[112:113], v[14:15]
    v_mov_b64 v[114:115], v[14:15]
    v_mov_b64 v[116:117], v[14:15]
    v_mov_b64 v[118:119], v[14:15]
    v_mov_b64 v[120:121], v[14:15]
    v_mov_b64 v[122:123], v[14:15]
    v_mov_b64 v[124:125], v[14:15]
    v_mov_b64 v[126:127], v[14:15]
    v_mov_b64 v[128:129], v[14:15]
    v_mov_b64 v[130:131], v[14:15]
    v_mov_b64 v[132:133], v[14:15]
    v_mov_b64 v[134:135], v[14:15]
    v_mov_b64 v[136:137], v[14:15]
    v_mov_b64 v[138:139], v[14:15]
    v_mov_b64 v[140:141], v[14:15]
    v_mov_b64 v[142:143], v[14:15]
    v_mov_b64 v[144:145], v[14:15]
    v_mov_b64 v[146:147], v[14:15]
    v_mov_b64 v[148:149], v[14:15]
    v_mov_b64 v[150:151], v[14:15]
    v_mov_b64 v[152:153], v[14:15]
    v_mov_b64 v[154:155], v[14:15]
    v_mov_b64 v[156:157], v[14:15]
    v_mov_b64 v[158:159], v[14:15]
    v_mov_b64 v[160:161], v[14:15]
    v_mov_b64 v[162:163], v[14:15]
    v_mov_b64 v[164:165], v[14:15]
    v_mov_b64 v[166:167], v[14:15]
    v_mov_b64 v[168:169], v[14:15]
    v_mov_b64 v[170:171], v[14:15]
    v_mov_b64 v[172:173], v[14:15]
    v_mov_b64 v[174:175], v[14:15]
    v_mov_b64 v[176:177], v[14:15]
    v_mov_b64 v[178:179], v[14:15]
    v_mov_b64 v[180:181], v[14:15]
    v_mov_b64 v[182:183], v[14:15]
    v_mov_b64 v[184:185], v[14:15]
    v_mov_b64 v[186:187], v[14:15]
    v_mov_b64 v[188:189], v[14:15]
    v_mov_b64 v[190:191], v[14:15]
    v_mov_b64 v[192:193], v[14:15]
    v_mov_b64 v[194:195], v[14:15]
    v_mov_b64 v[196:197], v[14:15]
    v_mov_b64 v[198:199], v[14:15]
    v_mov_b64 v[200:201], v[14:15]
    v_mov_b64 v[202:203], v[14:15]
    v_mov_b64 v[204:205], v[14:15]
    v_mov_b64 v[206:207], v[14:15]
    v_mov_b64 v[208:209], v[14:15]
    v_mov_b64 v[210:211], v[14:15]
    v_mov_b64 v[212:213], v[14:15]
    v_mov_b64 v[214:215], v[14:15]
    v_mov_b64 v[216:217], v[14:15]
    v_mov_b64 v[218:219], v[14:15]
    v_mov_b64 v[220:221], v[14:15]
    v_mov_b64 v[222:223], v[14:15]
    v_mov_b64 v[224:225], v[14:15]
    v_mov_b64 v[226:227], v[14:15]
    v_mov_b64 v[228:229], v[14:15]
    v_mov_b64 v[230:231], v[14:15]
    v_mov_b32 v11, 163824
    ds_write_b64 v11, v[14:15]
    v_mov_b32 v11, 163776
    ds_write_b64 v11, v[14:15] offset:0
    ds_write_b64 v11, v[14:15] offset:8
    ds_write_b64 v11, v[14:15] offset:16
    ds_write_b64 v11, v[14:15] offset:24
    ds_write_b64 v11, v[14:15] offset:32
    ds_write_b64 v11, v[14:15] offset:40
    s_waitcnt lgkmcnt(0)
    s_mul_i32 s50, s36, 3072
    s_add_u32 s50, s50, 147456
    s_lshr_b32 s51, s3, 2
    s_lshl_b32 s58, s51, 10
    s_add_u32 s58, s58, s50
    v_add_u32 v14, s58, v2
    s_lshl_b32 s37, s51, 1
    s_sub_u32 s37, 1, s37
    s_xor_b32 s51, s51, 1
    v_bfe_u32 v15, v1, 4, 1
    v_lshlrev_b32 v15, 3, v15
    v_lshl_add_u32 v15, v3, 4, v15
    v_xor_b32 v13, s51, v6
    v_lshl_add_u32 v15, v13, 8, v15
    v_add_u32 v15, s50, v15
    s_mov_b32 s54, 0
    s_mov_b32 s55, 47104
    s_mov_b32 s56, 4294873088
    s_mov_b32 s57, 0
    s_mov_b32 s52, 1069066811
    s_mov_b32 s53, 1069066811
    v_bfe_u32 v12, v1, 2, 2
    v_mul_u32_u24 v12, 40, v12
    v_mul_u32_u24 v13, 800, v4
    v_add_u32 v12, v12, v13
    v_and_b32 v13, 3, v1
    v_cmp_eq_u32 vcc, v13, v4
    v_mov_b32 v13, 3200
    s_nop 0
    v_cndmask_b32 v12, v13, v12, vcc
    v_add_u32 v237, 141312, v12
    s_lshl_b32 s59, s40, 2
    s_add_u32 s59, s59, s3
    s_lshl_b32 s58, s44, 1
    s_lshr_b32 s50, s40, 3
    s_add_u32 s58, s58, s50
    s_lshl_b32 s58, s58, 2
    s_add_u32 s58, s58, s3
    s_cmp_eq_u32 s42, 0
    s_cbranch_scc1 L_pre1
L_pre2:
    s_cmp_lt_u32 s41, 4
    s_cselect_b32 s50, 0, 6291456
    s_cselect_b32 s60, 1051011932, 1.0
    s_cselect_b32 s58, s59, s58
    s_mov_b32 s61, s60
    s_and_b32 s51, s41, 3
    s_mul_i32 s51, s51, 1441792
    s_add_u32 s50, s50, s51
    s_lshr_b32 s51, s58, 1
    s_mul_i32 s51, s51, 5632
    s_add_u32 s50, s50, s51
    s_and_b32 s51, s59, 1
    s_lshl_b32 s62, s51, 10
    s_add_u32 s62, s62, s50
    s_lshl_b32 s63, s51, 8
    s_add_u32 s63, s63, s50
    s_add_u32 s63, s63, 2048
    s_mov_b32 s51, 180224
    v_mul_lo_u32 v11, v4, s51
    v_lshl_add_u32 v232, v3, 4, v11
    s_mul_i32 s75, s41, 655360
    s_mul_i32 s51, s59, 2560
    s_add_u32 s75, s75, s51
    s_add_u32 s75, s75, 12582912
    s_mov_b32 s51, 163840
    v_mul_lo_u32 v11, v4, s51
    v_lshl_add_u32 v241, v3, 4, v11
    s_movk_i32 s76, 256
    s_barrier
    ds_read_b128 v[92:95], v9 offset:0
    ds_read_b128 v[96:99], v9 offset:2048
    ds_read_b64_tr_b16 v[32:33], v8 offset:10240
    ds_read_b64_tr_b16 v[34:35], v8 offset:12800
    ds_read_b64_tr_b16 v[36:37], v8 offset:10248
    ds_read_b64_tr_b16 v[38:39], v8 offset:12808
    ds_read_b64_tr_b16 v[40:41], v8 offset:10256
    ds_read_b64_tr_b16 v[42:43], v8 offset:12816
    ds_read_b64_tr_b16 v[44:45], v8 offset:10264
    ds_read_b64_tr_b16 v[46:47], v8 offset:12824
    ds_read_b64_tr_b16 v[48:49], v8 offset:10272
    ds_read_b64_tr_b16 v[50:51], v8 offset:12832
    ds_read_b64_tr_b16 v[52:53], v8 offset:15360
    ds_read_b64_tr_b16 v[54:55], v8 offset:17920
    ds_read_b64_tr_b16 v[56:57], v8 offset:15368
    ds_read_b64_tr_b16 v[58:59], v8 offset:17928
    s_waitcnt lgkmcnt(10)
.p2align 6
L_main2:
    v_mfma_f32_16x16x32_bf16 v[152:155], v[32:35], v[92:95], v[152:155]
    ds_read_b128 v[100:103], v10 offset:0
    ds_read_b128 v[104:107], v10 offset:2048
    v_mfma_f32_16x16x32_bf16 v[156:159], v[32:35], v[96:99], v[156:159]
    ds_read_b64_tr_b16 v[60:61], v8 offset:15376
    ds_read_b64_tr_b16 v[62:63], v8 offset:17936
    v_mfma_f32_16x16x32_bf16 v[160:163], v[36:39], v[92:95], v[160:163]
    ds_read_b64_tr_b16 v[64:65], v8 offset:15384
    v_mfma_f32_16x16x32_bf16 v[164:167], v[36:39], v[96:99], v[164:167]
    ds_read_b64_tr_b16 v[66:67], v8 offset:17944
    s_waitcnt lgkmcnt(12)
    v_mfma_f32_16x16x32_bf16 v[168:171], v[40:43], v[92:95], v[168:171]
    ds_read_b64_tr_b16 v[68:69], v8 offset:15392
    v_mfma_f32_16x16x32_bf16 v[172:175], v[40:43], v[96:99], v[172:175]
    ds_read_b64_tr_b16 v[70:71], v8 offset:17952
    v_mfma_f32_16x16x32_bf16 v[176:179], v[44:47], v[92:95], v[176:179]
    ds_read_b64_tr_b16 v[72:73], v8 offset:20480
    v_mfma_f32_16x16x32_bf16 v[180:183], v[44:47], v[96:99], v[180:183]
    ds_read_b64_tr_b16 v[74:75], v8 offset:23040
    s_waitcnt lgkmcnt(8)
    v_mfma_f32_16x16x32_bf16 v[184:187], v[48:51], v[92:95], v[184:187]
    ds_read_b64_tr_b16 v[76:77], v8 offset:20488
    v_mfma_f32_16x16x32_bf16 v[188:191], v[48:51], v[96:99], v[188:191]
    ds_read_b64_tr_b16 v[78:79], v8 offset:23048
    v_mfma_f32_16x16x32_bf16 v[152:155], v[52:55], v[100:103], v[152:155]
    ds_read_b64_tr_b16 v[80:81], v8 offset:20496
    v_mfma_f32_16x16x32_bf16 v[156:159], v[52:55], v[104:107], v[156:159]
    ds_read_b64_tr_b16 v[82:83], v8 offset:23056
    s_waitcnt lgkmcnt(10)
    v_mfma_f32_16x16x32_bf16 v[160:163], v[56:59], v[100:103], v[160:163]
    ds_read_b64_tr_b16 v[84:85], v8 offset:20504
    v_mfma_f32_16x16x32_bf16 v[164:167], v[56:59], v[104:107], v[164:167]
    ds_read_b64_tr_b16 v[86:87], v8 offset:23064
    v_mfma_f32_16x16x32_bf16 v[168:171], v[60:63], v[100:103], v[168:171]
    ds_read_b64_tr_b16 v[88:89], v8 offset:20512
    v_mfma_f32_16x16x32_bf16 v[172:175], v[60:63], v[104:107], v[172:175]
    ds_read_b64_tr_b16 v[90:91], v8 offset:23072
    s_waitcnt lgkmcnt(10)
    v_mfma_f32_16x16x32_bf16 v[176:179], v[64:67], v[100:103], v[176:179]
    ds_read_b64_tr_b16 v[32:33], v8 offset:25600
    v_mfma_f32_16x16x32_bf16 v[180:183], v[64:67], v[104:107], v[180:183]
    ds_read_b64_tr_b16 v[34:35], v8 offset:28160
    v_mfma_f32_16x16x32_bf16 v[184:187], v[68:71], v[100:103], v[184:187]
    ds_read_b64_tr_b16 v[36:37], v8 offset:25608
    v_mfma_f32_16x16x32_bf16 v[188:191], v[68:71], v[104:107], v[188:191]
    ds_read_b64_tr_b16 v[38:39], v8 offset:28168
    s_waitcnt lgkmcnt(10)
    v_mfma_f32_16x16x32_bf16 v[112:115], v[72:75], v[92:95], v[112:115]
    ds_read_b64_tr_b16 v[40:41], v8 offset:25616
    v_mfma_f32_16x16x32_bf16 v[116:119], v[72:75], v[96:99], v[116:119]
    ds_read_b64_tr_b16 v[42:43], v8 offset:28176
    v_mfma_f32_16x16x32_bf16 v[120:123], v[76:79], v[92:95], v[120:123]
    ds_read_b64_tr_b16 v[44:45], v8 offset:25624
    v_mfma_f32_16x16x32_bf16 v[124:127], v[76:79], v[96:99], v[124:127]
    ds_read_b64_tr_b16 v[46:47], v8 offset:28184
    s_waitcnt lgkmcnt(10)
    v_mfma_f32_16x16x32_bf16 v[128:131], v[80:83], v[92:95], v[128:131]
    ds_read_b64_tr_b16 v[48:49], v8 offset:25632
    v_mfma_f32_16x16x32_bf16 v[132:135], v[80:83], v[96:99], v[132:135]
    ds_read_b64_tr_b16 v[50:51], v8 offset:28192
    v_mfma_f32_16x16x32_bf16 v[136:139], v[84:87], v[92:95], v[136:139]
    ds_read_b64_tr_b16 v[52:53], v8 offset:0
    v_mfma_f32_16x16x32_bf16 v[140:143], v[84:87], v[96:99], v[140:143]
    ds_read_b64_tr_b16 v[54:55], v8 offset:2560
    s_waitcnt lgkmcnt(10)
    v_mfma_f32_16x16x32_bf16 v[144:147], v[88:91], v[92:95], v[144:147]
    ds_read_b64_tr_b16 v[56:57], v8 offset:8
    v_mfma_f32_16x16x32_bf16 v[148:151], v[88:91], v[96:99], v[148:151]
    ds_read_b64_tr_b16 v[58:59], v8 offset:2568
    v_mfma_f32_16x16x32_bf16 v[112:115], v[32:35], v[100:103], v[112:115]
    ds_read_b64_tr_b16 v[60:61], v8 offset:16
    v_mfma_f32_16x16x32_bf16 v[116:119], v[32:35], v[104:107], v[116:119]
    ds_read_b64_tr_b16 v[62:63], v8 offset:2576
    s_waitcnt lgkmcnt(10)
    v_mfma_f32_16x16x32_bf16 v[120:123], v[36:39], v[100:103], v[120:123]
    ds_read_b64_tr_b16 v[64:65], v8 offset:24
    v_mfma_f32_16x16x32_bf16 v[124:127], v[36:39], v[104:107], v[124:127]
    ds_read_b64_tr_b16 v[66:67], v8 offset:2584
    v_mfma_f32_16x16x32_bf16 v[128:131], v[40:43], v[100:103], v[128:131]
    ds_read_b64_tr_b16 v[68:69], v8 offset:32
    v_mfma_f32_16x16x32_bf16 v[132:135], v[40:43], v[104:107], v[132:135]
    ds_read_b64_tr_b16 v[70:71], v8 offset:2592
    s_waitcnt lgkmcnt(10)
    v_mfma_f32_16x16x32_bf16 v[136:139], v[44:47], v[100:103], v[136:139]
    ds_read_b64_tr_b16 v[72:73], v8 offset:5120
    v_mfma_f32_16x16x32_bf16 v[140:143], v[44:47], v[104:107], v[140:143]
    ds_read_b64_tr_b16 v[74:75], v8 offset:7680
    v_mfma_f32_16x16x32_bf16 v[144:147], v[48:51], v[100:103], v[144:147]
    ds_read_b64_tr_b16 v[76:77], v8 offset:5128
    v_mfma_f32_16x16x32_bf16 v[148:151], v[48:51], v[104:107], v[148:151]
    ds_read_b64_tr_b16 v[78:79], v8 offset:7688
    s_waitcnt lgkmcnt(10)
    v_mfma_f32_16x16x32_bf16 v[192:195], v[52:55], v[92:95], v[192:195]
    ds_read_b64_tr_b16 v[80:81], v8 offset:5136
    v_mfma_f32_16x16x32_bf16 v[196:199], v[52:55], v[96:99], v[196:199]
    ds_read_b64_tr_b16 v[82:83], v8 offset:7696
    v_mfma_f32_16x16x32_bf16 v[200:203], v[56:59], v[92:95], v[200:203]
    ds_read_b64_tr_b16 v[84:85], v8 offset:5144
    v_mfma_f32_16x16x32_bf16 v[204:207], v[56:59], v[96:99], v[204:207]
    ds_read_b64_tr_b16 v[86:87], v8 offset:7704
    s_waitcnt lgkmcnt(10)
    v_mfma_f32_16x16x32_bf16 v[208:211], v[60:63], v[92:95], v[208:211]
    ds_read_b64_tr_b16 v[88:89], v8 offset:5152
    v_mfma_f32_16x16x32_bf16 v[212:215], v[60:63], v[96:99], v[212:215]
    ds_read_b64_tr_b16 v[90:91], v8 offset:7712
    v_mfma_f32_16x16x32_bf16 v[216:219], v[64:67], v[92:95], v[216:219]
    s_add_u32 s57, s57, 1
    s_cmp_eq_u32 s57, 3
    v_mfma_f32_16x16x32_bf16 v[220:223], v[64:67], v[96:99], v[220:223]
    s_cselect_b32 s58, s56, s55
    s_cselect_b32 s57, 0, s57
    s_waitcnt lgkmcnt(8)
    v_mfma_f32_16x16x32_bf16 v[224:227], v[68:71], v[92:95], v[224:227]
    v_add_u32 v8, s58, v8
    v_add_u32 v9, s58, v9
    v_mfma_f32_16x16x32_bf16 v[228:231], v[68:71], v[96:99], v[228:231]
    v_add_u32 v10, s58, v10
    v_mfma_f32_16x16x32_bf16 v[192:195], v[72:75], v[100:103], v[192:195]
    s_waitcnt lgkmcnt(0)
    s_barrier
    v_mfma_f32_16x16x32_bf16 v[196:199], v[72:75], v[104:107], v[196:199]
    ds_read_b128 v[92:95], v9 offset:0
    ds_read_b128 v[96:99], v9 offset:2048
    v_mfma_f32_16x16x32_bf16 v[200:203], v[76:79], v[100:103], v[200:203]
    ds_read_b64_tr_b16 v[32:33], v8 offset:10240
    ds_read_b64_tr_b16 v[34:35], v8 offset:12800
    v_mfma_f32_16x16x32_bf16 v[204:207], v[76:79], v[104:107], v[204:207]
    ds_read_b64_tr_b16 v[36:37], v8 offset:10248
    ds_read_b64_tr_b16 v[38:39], v8 offset:12808
    v_mfma_f32_16x16x32_bf16 v[208:211], v[80:83], v[100:103], v[208:211]
    ds_read_b64_tr_b16 v[40:41], v8 offset:10256
    ds_read_b64_tr_b16 v[42:43], v8 offset:12816
    v_mfma_f32_16x16x32_bf16 v[212:215], v[80:83], v[104:107], v[212:215]
    ds_read_b64_tr_b16 v[44:45], v8 offset:10264
    ds_read_b64_tr_b16 v[46:47], v8 offset:12824
    v_mfma_f32_16x16x32_bf16 v[216:219], v[84:87], v[100:103], v[216:219]
    ds_read_b64_tr_b16 v[48:49], v8 offset:10272
    ds_read_b64_tr_b16 v[50:51], v8 offset:12832
    v_mfma_f32_16x16x32_bf16 v[220:223], v[84:87], v[104:107], v[220:223]
    ds_read_b64_tr_b16 v[52:53], v8 offset:15360
    ds_read_b64_tr_b16 v[54:55], v8 offset:17920
    v_mfma_f32_16x16x32_bf16 v[224:227], v[88:91], v[100:103], v[224:227]
    ds_read_b64_tr_b16 v[56:57], v8 offset:15368
    v_mfma_f32_16x16x32_bf16 v[228:231], v[88:91], v[104:107], v[228:231]
    ds_read_b64_tr_b16 v[58:59], v8 offset:17928
    s_add_u32 s54, s54, 1
    s_cmp_lt_u32 s54, 7
    s_waitcnt lgkmcnt(10)
    s_cbranch_scc1 L_main2
    s_lshl_b32 s50, s39, 7
    s_add_u32 s50, s50, 29425664
    v_mov_b32 v16, 0
    v_mov_b32 v17, 0
    s_cmp_eq_u32 s3, 1
    s_cselect_b64 exec, 0xffff, 0
    buffer_store_dwordx2 v[16:17], v253, s[28:31], s50 offen sc1
    buffer_store_dwordx2 v[16:17], v253, s[28:31], s72 offen sc1
    s_mov_b64 exec, -1
    v_mfma_f32_16x16x32_bf16 v[152:155], v[32:35], v[92:95], v[152:155]
    ds_read_b128 v[100:103], v10 offset:0
    ds_read_b128 v[104:107], v10 offset:2048
    v_mfma_f32_16x16x32_bf16 v[156:159], v[32:35], v[96:99], v[156:159]
    ds_read_b64_tr_b16 v[60:61], v8 offset:15376
    ds_read_b64_tr_b16 v[62:63], v8 offset:17936
    v_mfma_f32_16x16x32_bf16 v[160:163], v[36:39], v[92:95], v[160:163]
    ds_read_b64_tr_b16 v[64:65], v8 offset:15384
    v_mfma_f32_16x16x32_bf16 v[164:167], v[36:39], v[96:99], v[164:167]
    ds_read_b64_tr_b16 v[66:67], v8 offset:17944
    s_waitcnt lgkmcnt(12)
    v_mfma_f32_16x16x32_bf16 v[168:171], v[40:43], v[92:95], v[168:171]
    ds_read_b64_tr_b16 v[68:69], v8 offset:15392
    v_mfma_f32_16x16x32_bf16 v[172:175], v[40:43], v[96:99], v[172:175]
    ds_read_b64_tr_b16 v[70:71], v8 offset:17952
    v_mfma_f32_16x16x32_bf16 v[176:179], v[44:47], v[92:95], v[176:179]
    ds_read_b64_tr_b16 v[72:73], v8 offset:20480
    v_mfma_f32_16x16x32_bf16 v[180:183], v[44:47], v[96:99], v[180:183]
    ds_read_b64_tr_b16 v[74:75], v8 offset:23040
    s_waitcnt lgkmcnt(8)
    v_mfma_f32_16x16x32_bf16 v[184:187], v[48:51], v[92:95], v[184:187]
    ds_read_b64_tr_b16 v[76:77], v8 offset:20488
    v_mfma_f32_16x16x32_bf16 v[188:191], v[48:51], v[96:99], v[188:191]
    ds_read_b64_tr_b16 v[78:79], v8 offset:23048
    v_mfma_f32_16x16x32_bf16 v[152:155], v[52:55], v[100:103], v[152:155]
    ds_read_b64_tr_b16 v[80:81], v8 offset:20496
    v_mfma_f32_16x16x32_bf16 v[156:159], v[52:55], v[104:107], v[156:159]
    ds_read_b64_tr_b16 v[82:83], v8 offset:23056
    s_waitcnt lgkmcnt(10)
    v_mfma_f32_16x16x32_bf16 v[160:163], v[56:59], v[100:103], v[160:163]
    ds_read_b64_tr_b16 v[84:85], v8 offset:20504
    v_mfma_f32_16x16x32_bf16 v[164:167], v[56:59], v[104:107], v[164:167]
    ds_read_b64_tr_b16 v[86:87], v8 offset:23064
    v_mfma_f32_16x16x32_bf16 v[168:171], v[60:63], v[100:103], v[168:171]
    ds_read_b64_tr_b16 v[88:89], v8 offset:20512
    v_mfma_f32_16x16x32_bf16 v[172:175], v[60:63], v[104:107], v[172:175]
    ds_read_b64_tr_b16 v[90:91], v8 offset:23072
    s_waitcnt lgkmcnt(10)
    v_mfma_f32_16x16x32_bf16 v[176:179], v[64:67], v[100:103], v[176:179]
    ds_read_b64_tr_b16 v[32:33], v8 offset:25600
    v_mfma_f32_16x16x32_bf16 v[180:183], v[64:67], v[104:107], v[180:183]
    ds_read_b64_tr_b16 v[34:35], v8 offset:28160
    v_mfma_f32_16x16x32_bf16 v[184:187], v[68:71], v[100:103], v[184:187]
    ds_read_b64_tr_b16 v[36:37], v8 offset:25608
    v_mfma_f32_16x16x32_bf16 v[188:191], v[68:71], v[104:107], v[188:191]
    ds_read_b64_tr_b16 v[38:39], v8 offset:28168
    s_waitcnt lgkmcnt(10)
    v_mfma_f32_16x16x32_bf16 v[112:115], v[72:75], v[92:95], v[112:115]
    ds_read_b64_tr_b16 v[40:41], v8 offset:25616
    v_mfma_f32_16x16x32_bf16 v[116:119], v[72:75], v[96:99], v[116:119]
    ds_read_b64_tr_b16 v[42:43], v8 offset:28176
    v_mfma_f32_16x16x32_bf16 v[120:123], v[76:79], v[92:95], v[120:123]
    ds_read_b64_tr_b16 v[44:45], v8 offset:25624
    v_mfma_f32_16x16x32_bf16 v[124:127], v[76:79], v[96:99], v[124:127]
    ds_read_b64_tr_b16 v[46:47], v8 offset:28184
    s_waitcnt lgkmcnt(10)
    v_mfma_f32_16x16x32_bf16 v[128:131], v[80:83], v[92:95], v[128:131]
    ds_read_b64_tr_b16 v[48:49], v8 offset:25632
    v_mfma_f32_16x16x32_bf16 v[132:135], v[80:83], v[96:99], v[132:135]
    ds_read_b64_tr_b16 v[50:51], v8 offset:28192
    v_mfma_f32_16x16x32_bf16 v[136:139], v[84:87], v[92:95], v[136:139]
    v_mfma_f32_16x16x32_bf16 v[140:143], v[84:87], v[96:99], v[140:143]
    s_waitcnt lgkmcnt(8)
    v_mfma_f32_16x16x32_bf16 v[144:147], v[88:91], v[92:95], v[144:147]
    v_add_u32 v8, 47104, v8
    v_add_u32 v9, 47104, v9
    v_mfma_f32_16x16x32_bf16 v[148:151], v[88:91], v[96:99], v[148:151]
    v_add_u32 v10, 47104, v10
    v_mfma_f32_16x16x32_bf16 v[112:115], v[32:35], v[100:103], v[112:115]
    s_waitcnt lgkmcnt(0)
    s_barrier
    v_mfma_f32_16x16x32_bf16 v[116:119], v[32:35], v[104:107], v[116:119]
    ds_read_b128 v[92:95], v9 offset:0
    ds_read_b128 v[96:99], v9 offset:2048
    v_mfma_f32_16x16x32_bf16 v[120:123], v[36:39], v[100:103], v[120:123]
    ds_read_b64_tr_b16 v[52:53], v8 offset:10240
    ds_read_b64_tr_b16 v[54:55], v8 offset:12800
    v_mfma_f32_16x16x32_bf16 v[124:127], v[36:39], v[104:107], v[124:127]
    ds_read_b64_tr_b16 v[56:57], v8 offset:10248
    ds_read_b64_tr_b16 v[58:59], v8 offset:12808
    v_mfma_f32_16x16x32_bf16 v[128:131], v[40:43], v[100:103], v[128:131]
    ds_read_b64_tr_b16 v[60:61], v8 offset:10256
    ds_read_b64_tr_b16 v[62:63], v8 offset:12816
    v_mfma_f32_16x16x32_bf16 v[132:135], v[40:43], v[104:107], v[132:135]
    ds_read_b64_tr_b16 v[64:65], v8 offset:10264
    ds_read_b64_tr_b16 v[66:67], v8 offset:12824
    v_mfma_f32_16x16x32_bf16 v[136:139], v[44:47], v[100:103], v[136:139]
    ds_read_b64_tr_b16 v[68:69], v8 offset:10272
    ds_read_b64_tr_b16 v[70:71], v8 offset:12832
    v_mfma_f32_16x16x32_bf16 v[140:143], v[44:47], v[104:107], v[140:143]
    ds_read_b64_tr_b16 v[72:73], v8 offset:15360
    ds_read_b64_tr_b16 v[74:75], v8 offset:17920
    v_mfma_f32_16x16x32_bf16 v[144:147], v[48:51], v[100:103], v[144:147]
    ds_read_b64_tr_b16 v[76:77], v8 offset:15368
    v_mfma_f32_16x16x32_bf16 v[148:151], v[48:51], v[104:107], v[148:151]
    ds_read_b64_tr_b16 v[78:79], v8 offset:17928
    s_waitcnt lgkmcnt(10)
    v_mfma_f32_16x16x32_bf16 v[152:155], v[52:55], v[92:95], v[152:155]
    ds_read_b128 v[100:103], v10 offset:0
    ds_read_b128 v[104:107], v10 offset:2048
    v_mfma_f32_16x16x32_bf16 v[156:159], v[52:55], v[96:99], v[156:159]
    ds_read_b64_tr_b16 v[80:81], v8 offset:15376
    ds_read_b64_tr_b16 v[82:83], v8 offset:17936
    v_mfma_f32_16x16x32_bf16 v[160:163], v[56:59], v[92:95], v[160:163]
    ds_read_b64_tr_b16 v[84:85], v8 offset:15384
    v_mfma_f32_16x16x32_bf16 v[164:167], v[56:59], v[96:99], v[164:167]
    ds_read_b64_tr_b16 v[86:87], v8 offset:17944
    s_waitcnt lgkmcnt(12)
    v_mfma_f32_16x16x32_bf16 v[168:171], v[60:63], v[92:95], v[168:171]
    ds_read_b64_tr_b16 v[88:89], v8 offset:15392
    v_mfma_f32_16x16x32_bf16 v[172:175], v[60:63], v[96:99], v[172:175]
    ds_read_b64_tr_b16 v[90:91], v8 offset:17952
    v_mfma_f32_16x16x32_bf16 v[176:179], v[64:67], v[92:95], v[176:179]
    ds_read_b64_tr_b16 v[32:33], v8 offset:20480
    v_mfma_f32_16x16x32_bf16 v[180:183], v[64:67], v[96:99], v[180:183]
    ds_read_b64_tr_b16 v[34:35], v8 offset:23040
    s_waitcnt lgkmcnt(8)
    v_mfma_f32_16x16x32_bf16 v[184:187], v[68:71], v[92:95], v[184:187]
    ds_read_b64_tr_b16 v[36:37], v8 offset:20488
    v_mfma_f32_16x16x32_bf16 v[188:191], v[68:71], v[96:99], v[188:191]
    ds_read_b64_tr_b16 v[38:39], v8 offset:23048
    v_mfma_f32_16x16x32_bf16 v[152:155], v[72:75], v[100:103], v[152:155]
    ds_read_b64_tr_b16 v[40:41], v8 offset:20496
    v_mfma_f32_16x16x32_bf16 v[156:159], v[72:75], v[104:107], v[156:159]
    ds_read_b64_tr_b16 v[42:43], v8 offset:23056
    s_waitcnt lgkmcnt(10)
    v_mfma_f32_16x16x32_bf16 v[160:163], v[76:79], v[100:103], v[160:163]
    ds_read_b64_tr_b16 v[44:45], v8 offset:20504
    v_mfma_f32_16x16x32_bf16 v[164:167], v[76:79], v[104:107], v[164:167]
    ds_read_b64_tr_b16 v[46:47], v8 offset:23064
    v_mfma_f32_16x16x32_bf16 v[168:171], v[80:83], v[100:103], v[168:171]
    ds_read_b64_tr_b16 v[48:49], v8 offset:20512
    v_mfma_f32_16x16x32_bf16 v[172:175], v[80:83], v[104:107], v[172:175]
    ds_read_b64_tr_b16 v[50:51], v8 offset:23072
    s_waitcnt lgkmcnt(10)
    v_mfma_f32_16x16x32_bf16 v[176:179], v[84:87], v[100:103], v[176:179]
    ds_read_b64_tr_b16 v[52:53], v8 offset:25600
    v_mfma_f32_16x16x32_bf16 v[180:183], v[84:87], v[104:107], v[180:183]
    ds_read_b64_tr_b16 v[54:55], v8 offset:28160
    v_mfma_f32_16x16x32_bf16 v[184:187], v[88:91], v[100:103], v[184:187]
    ds_read_b64_tr_b16 v[56:57], v8 offset:25608
    v_mfma_f32_16x16x32_bf16 v[188:191], v[88:91], v[104:107], v[188:191]
    ds_read_b64_tr_b16 v[58:59], v8 offset:28168
    s_waitcnt lgkmcnt(10)
    v_mfma_f32_16x16x32_bf16 v[112:115], v[32:35], v[92:95], v[112:115]
    ds_read_b64_tr_b16 v[60:61], v8 offset:25616
    v_mfma_f32_16x16x32_bf16 v[116:119], v[32:35], v[96:99], v[116:119]
    ds_read_b64_tr_b16 v[62:63], v8 offset:28176
    v_mfma_f32_16x16x32_bf16 v[120:123], v[36:39], v[92:95], v[120:123]
    ds_read_b64_tr_b16 v[64:65], v8 offset:25624
    v_mfma_f32_16x16x32_bf16 v[124:127], v[36:39], v[96:99], v[124:127]
    ds_read_b64_tr_b16 v[66:67], v8 offset:28184
    s_waitcnt lgkmcnt(10)
    v_mfma_f32_16x16x32_bf16 v[128:131], v[40:43], v[92:95], v[128:131]
    ds_read_b64_tr_b16 v[68:69], v8 offset:25632
    v_mfma_f32_16x16x32_bf16 v[132:135], v[40:43], v[96:99], v[132:135]
    ds_read_b64_tr_b16 v[70:71], v8 offset:28192
    v_mfma_f32_16x16x32_bf16 v[136:139], v[44:47], v[92:95], v[136:139]
    v_mfma_f32_16x16x32_bf16 v[140:143], v[44:47], v[96:99], v[140:143]
    s_waitcnt lgkmcnt(8)
    v_mfma_f32_16x16x32_bf16 v[144:147], v[48:51], v[92:95], v[144:147]
    v_add_u32 v8, 4294873088, v8
    v_add_u32 v9, 4294873088, v9
    v_mfma_f32_16x16x32_bf16 v[148:151], v[48:51], v[96:99], v[148:151]
    v_add_u32 v10, 4294873088, v10
    v_mfma_f32_16x16x32_bf16 v[112:115], v[52:55], v[100:103], v[112:115]
    s_waitcnt lgkmcnt(0)
    s_barrier
    v_mfma_f32_16x16x32_bf16 v[116:119], v[52:55], v[104:107], v[116:119]
    ds_read_b128 v[92:95], v9 offset:0
    ds_read_b128 v[96:99], v9 offset:2048
    v_mfma_f32_16x16x32_bf16 v[120:123], v[56:59], v[100:103], v[120:123]
    ds_read_b64_tr_b16 v[72:73], v8 offset:10240
    ds_read_b64_tr_b16 v[74:75], v8 offset:12800
    v_mfma_f32_16x16x32_bf16 v[124:127], v[56:59], v[104:107], v[124:127]
    ds_read_b64_tr_b16 v[76:77], v8 offset:10248
    ds_read_b64_tr_b16 v[78:79], v8 offset:12808
    v_mfma_f32_16x16x32_bf16 v[128:131], v[60:63], v[100:103], v[128:131]
    ds_read_b64_tr_b16 v[80:81], v8 offset:10256
    ds_read_b64_tr_b16 v[82:83], v8 offset:12816
    v_mfma_f32_16x16x32_bf16 v[132:135], v[60:63], v[104:107], v[132:135]
    ds_read_b64_tr_b16 v[84:85], v8 offset:10264
    ds_read_b64_tr_b16 v[86:87], v8 offset:12824
    v_mfma_f32_16x16x32_bf16 v[136:139], v[64:67], v[100:103], v[136:139]
    ds_read_b64_tr_b16 v[88:89], v8 offset:10272
    ds_read_b64_tr_b16 v[90:91], v8 offset:12832
    v_mfma_f32_16x16x32_bf16 v[140:143], v[64:67], v[104:107], v[140:143]
    ds_read_b64_tr_b16 v[32:33], v8 offset:15360
    ds_read_b64_tr_b16 v[34:35], v8 offset:17920
    v_mfma_f32_16x16x32_bf16 v[144:147], v[68:71], v[100:103], v[144:147]
    ds_read_b64_tr_b16 v[36:37], v8 offset:15368
    v_mfma_f32_16x16x32_bf16 v[148:151], v[68:71], v[104:107], v[148:151]
    ds_read_b64_tr_b16 v[38:39], v8 offset:17928
    s_waitcnt lgkmcnt(10)
    v_mfma_f32_16x16x32_bf16 v[152:155], v[72:75], v[92:95], v[152:155]
    ds_read_b128 v[100:103], v10 offset:0
    ds_read_b128 v[104:107], v10 offset:2048
    v_mfma_f32_16x16x32_bf16 v[156:159], v[72:75], v[96:99], v[156:159]
    ds_read_b64_tr_b16 v[40:41], v8 offset:15376
    ds_read_b64_tr_b16 v[42:43], v8 offset:17936
    v_mfma_f32_16x16x32_bf16 v[160:163], v[76:79], v[92:95], v[160:163]
    ds_read_b64_tr_b16 v[44:45], v8 offset:15384
    v_mfma_f32_16x16x32_bf16 v[164:167], v[76:79], v[96:99], v[164:167]
    ds_read_b64_tr_b16 v[46:47], v8 offset:17944
    s_waitcnt lgkmcnt(12)
    v_mfma_f32_16x16x32_bf16 v[168:171], v[80:83], v[92:95], v[168:171]
    ds_read_b64_tr_b16 v[48:49], v8 offset:15392
    v_mfma_f32_16x16x32_bf16 v[172:175], v[80:83], v[96:99], v[172:175]
    ds_read_b64_tr_b16 v[50:51], v8 offset:17952
    v_mfma_f32_16x16x32_bf16 v[176:179], v[84:87], v[92:95], v[176:179]
    ds_read_b64_tr_b16 v[52:53], v8 offset:20480
    v_mfma_f32_16x16x32_bf16 v[180:183], v[84:87], v[96:99], v[180:183]
    ds_read_b64_tr_b16 v[54:55], v8 offset:23040
    s_waitcnt lgkmcnt(8)
    v_mfma_f32_16x16x32_bf16 v[184:187], v[88:91], v[92:95], v[184:187]
    ds_read_b64_tr_b16 v[56:57], v8 offset:20488
    v_mfma_f32_16x16x32_bf16 v[188:191], v[88:91], v[96:99], v[188:191]
    ds_read_b64_tr_b16 v[58:59], v8 offset:23048
    v_mfma_f32_16x16x32_bf16 v[152:155], v[32:35], v[100:103], v[152:155]
    ds_read_b64_tr_b16 v[60:61], v8 offset:20496
    v_mfma_f32_16x16x32_bf16 v[156:159], v[32:35], v[104:107], v[156:159]
    ds_read_b64_tr_b16 v[62:63], v8 offset:23056
    s_waitcnt lgkmcnt(10)
    v_mfma_f32_16x16x32_bf16 v[160:163], v[36:39], v[100:103], v[160:163]
    ds_read_b64_tr_b16 v[64:65], v8 offset:20504
    v_mfma_f32_16x16x32_bf16 v[164:167], v[36:39], v[104:107], v[164:167]
    ds_read_b64_tr_b16 v[66:67], v8 offset:23064
    v_mfma_f32_16x16x32_bf16 v[168:171], v[40:43], v[100:103], v[168:171]
    ds_read_b64_tr_b16 v[68:69], v8 offset:20512
    v_mfma_f32_16x16x32_bf16 v[172:175], v[40:43], v[104:107], v[172:175]
    ds_read_b64_tr_b16 v[70:71], v8 offset:23072
    s_waitcnt lgkmcnt(10)
    v_mfma_f32_16x16x32_bf16 v[176:179], v[44:47], v[100:103], v[176:179]
    ds_read_b64_tr_b16 v[72:73], v8 offset:25600
    v_mfma_f32_16x16x32_bf16 v[180:183], v[44:47], v[104:107], v[180:183]
    ds_read_b64_tr_b16 v[74:75], v8 offset:28160
    v_mfma_f32_16x16x32_bf16 v[184:187], v[48:51], v[100:103], v[184:187]
    ds_read_b64_tr_b16 v[76:77], v8 offset:25608
    v_mfma_f32_16x16x32_bf16 v[188:191], v[48:51], v[104:107], v[188:191]
    ds_read_b64_tr_b16 v[78:79], v8 offset:28168
    s_waitcnt lgkmcnt(10)
    v_mfma_f32_16x16x32_bf16 v[112:115], v[52:55], v[92:95], v[112:115]
    ds_read_b64_tr_b16 v[80:81], v8 offset:25616
    v_mfma_f32_16x16x32_bf16 v[116:119], v[52:55], v[96:99], v[116:119]
    ds_read_b64_tr_b16 v[82:83], v8 offset:28176
    v_mfma_f32_16x16x32_bf16 v[120:123], v[56:59], v[92:95], v[120:123]
    ds_read_b64_tr_b16 v[84:85], v8 offset:25624
    v_pk_mul_f32 v[152:153], v[152:153], s[60:61]
    v_pk_mul_f32 v[154:155], v[154:155], s[60:61]
    v_cvt_pk_bf16_f32 v16, v152, v153
    v_cvt_pk_bf16_f32 v17, v154, v155
    v_pk_mul_f32 v[160:161], v[160:161], s[60:61]
    v_pk_mul_f32 v[162:163], v[162:163], s[60:61]
    v_cvt_pk_bf16_f32 v18, v160, v161
    v_cvt_pk_bf16_f32 v19, v162, v163
    buffer_store_dwordx4 v[16:19], v232, s[28:31], s62 offen offset:0 sc1
    v_pk_mul_f32 v[168:169], v[168:169], s[60:61]
    v_pk_mul_f32 v[170:171], v[170:171], s[60:61]
    v_cvt_pk_bf16_f32 v20, v168, v169
    v_cvt_pk_bf16_f32 v21, v170, v171
    v_pk_mul_f32 v[176:177], v[176:177], s[60:61]
    v_pk_mul_f32 v[178:179], v[178:179], s[60:61]
    v_cvt_pk_bf16_f32 v22, v176, v177
    v_cvt_pk_bf16_f32 v23, v178, v179
    buffer_store_dwordx4 v[20:23], v232, s[28:31], s62 offen offset:512 sc1
    v_pk_mul_f32 v[184:185], v[184:185], s[60:61]
    v_pk_mul_f32 v[186:187], v[186:187], s[60:61]
    v_cvt_pk_bf16_f32 v108, v184, v185
    v_cvt_pk_bf16_f32 v109, v186, v187
    v_pk_mul_f32 v[156:157], v[156:157], s[60:61]
    v_pk_mul_f32 v[158:159], v[158:159], s[60:61]
    v_cvt_pk_bf16_f32 v24, v156, v157
    v_cvt_pk_bf16_f32 v25, v158, v159
    v_pk_mul_f32 v[164:165], v[164:165], s[60:61]
    v_pk_mul_f32 v[166:167], v[166:167], s[60:61]
    v_cvt_pk_bf16_f32 v26, v164, v165
    v_cvt_pk_bf16_f32 v27, v166, v167
    buffer_store_dwordx4 v[24:27], v232, s[28:31], s62 offen offset:256 sc1
    v_pk_mul_f32 v[172:173], v[172:173], s[60:61]
    v_pk_mul_f32 v[174:175], v[174:175], s[60:61]
    v_cvt_pk_bf16_f32 v28, v172, v173
    v_cvt_pk_bf16_f32 v29, v174, v175
    v_pk_mul_f32 v[180:181], v[180:181], s[60:61]
    v_pk_mul_f32 v[182:183], v[182:183], s[60:61]
    v_cvt_pk_bf16_f32 v30, v180, v181
    v_cvt_pk_bf16_f32 v31, v182, v183
    buffer_store_dwordx4 v[28:31], v232, s[28:31], s62 offen offset:768 sc1
    v_pk_mul_f32 v[188:189], v[188:189], s[60:61]
    v_pk_mul_f32 v[190:191], v[190:191], s[60:61]
    v_cvt_pk_bf16_f32 v110, v188, v189
    v_cvt_pk_bf16_f32 v111, v190, v191
    buffer_store_dwordx4 v[108:111], v232, s[28:31], s63 offen sc1
    s_add_u32 s62, s62, 720896
    s_add_u32 s63, s63, 720896
    v_mfma_f32_16x16x32_bf16 v[124:127], v[56:59], v[96:99], v[124:127]
    ds_read_b64_tr_b16 v[86:87], v8 offset:28184
    s_waitcnt lgkmcnt(10)
    v_mfma_f32_16x16x32_bf16 v[128:131], v[60:63], v[92:95], v[128:131]
    ds_read_b64_tr_b16 v[88:89], v8 offset:25632
    v_mfma_f32_16x16x32_bf16 v[132:135], v[60:63], v[96:99], v[132:135]
    ds_read_b64_tr_b16 v[90:91], v8 offset:28192
    v_mfma_f32_16x16x32_bf16 v[136:139], v[64:67], v[92:95], v[136:139]
    v_mfma_f32_16x16x32_bf16 v[140:143], v[64:67], v[96:99], v[140:143]
    s_waitcnt lgkmcnt(8)
    v_mfma_f32_16x16x32_bf16 v[144:147], v[68:71], v[92:95], v[144:147]
    v_mfma_f32_16x16x32_bf16 v[148:151], v[68:71], v[96:99], v[148:151]
    v_mfma_f32_16x16x32_bf16 v[112:115], v[72:75], v[100:103], v[112:115]
    v_mfma_f32_16x16x32_bf16 v[116:119], v[72:75], v[104:107], v[116:119]
    s_waitcnt lgkmcnt(4)
    v_mfma_f32_16x16x32_bf16 v[120:123], v[76:79], v[100:103], v[120:123]
    v_mfma_f32_16x16x32_bf16 v[124:127], v[76:79], v[104:107], v[124:127]
    v_mfma_f32_16x16x32_bf16 v[128:131], v[80:83], v[100:103], v[128:131]
    v_mfma_f32_16x16x32_bf16 v[132:135], v[80:83], v[104:107], v[132:135]
    s_waitcnt lgkmcnt(0)
    v_mfma_f32_16x16x32_bf16 v[136:139], v[84:87], v[100:103], v[136:139]
    v_mfma_f32_16x16x32_bf16 v[140:143], v[84:87], v[104:107], v[140:143]
    v_mfma_f32_16x16x32_bf16 v[144:147], v[88:91], v[100:103], v[144:147]
    v_mfma_f32_16x16x32_bf16 v[148:151], v[88:91], v[104:107], v[148:151]
    v_pk_mul_f32 v[112:113], v[112:113], s[60:61]
    v_pk_mul_f32 v[114:115], v[114:115], s[60:61]
    v_cvt_pk_bf16_f32 v152, v112, v113
    v_cvt_pk_bf16_f32 v153, v114, v115
    v_pk_mul_f32 v[120:121], v[120:121], s[60:61]
    v_pk_mul_f32 v[122:123], v[122:123], s[60:61]
    v_cvt_pk_bf16_f32 v154, v120, v121
    v_cvt_pk_bf16_f32 v155, v122, v123
    buffer_store_dwordx4 v[152:155], v232, s[28:31], s62 offen offset:0 sc1
    v_pk_mul_f32 v[128:129], v[128:129], s[60:61]
    v_pk_mul_f32 v[130:131], v[130:131], s[60:61]
    v_cvt_pk_bf16_f32 v156, v128, v129
    v_cvt_pk_bf16_f32 v157, v130, v131
    v_pk_mul_f32 v[136:137], v[136:137], s[60:61]
    v_pk_mul_f32 v[138:139], v[138:139], s[60:61]
    v_cvt_pk_bf16_f32 v158, v136, v137
    v_cvt_pk_bf16_f32 v159, v138, v139
    buffer_store_dwordx4 v[156:159], v232, s[28:31], s62 offen offset:512 sc1
    v_pk_mul_f32 v[144:145], v[144:145], s[60:61]
    v_pk_mul_f32 v[146:147], v[146:147], s[60:61]
    v_cvt_pk_bf16_f32 v168, v144, v145
    v_cvt_pk_bf16_f32 v169, v146, v147
    v_pk_mul_f32 v[116:117], v[116:117], s[60:61]
    v_pk_mul_f32 v[118:119], v[118:119], s[60:61]
    v_cvt_pk_bf16_f32 v160, v116, v117
    v_cvt_pk_bf16_f32 v161, v118, v119
    v_pk_mul_f32 v[124:125], v[124:125], s[60:61]
    v_pk_mul_f32 v[126:127], v[126:127], s[60:61]
    v_cvt_pk_bf16_f32 v162, v124, v125
    v_cvt_pk_bf16_f32 v163, v126, v127
    buffer_store_dwordx4 v[160:163], v232, s[28:31], s62 offen offset:256 sc1
    v_pk_mul_f32 v[132:133], v[132:133], s[60:61]
    v_pk_mul_f32 v[134:135], v[134:135], s[60:61]
    v_cvt_pk_bf16_f32 v164, v132, v133
    v_cvt_pk_bf16_f32 v165, v134, v135
    v_pk_mul_f32 v[140:141], v[140:141], s[60:61]
    v_pk_mul_f32 v[142:143], v[142:143], s[60:61]
    v_cvt_pk_bf16_f32 v166, v140, v141
    v_cvt_pk_bf16_f32 v167, v142, v143
    buffer_store_dwordx4 v[164:167], v232, s[28:31], s62 offen offset:768 sc1
    v_pk_mul_f32 v[148:149], v[148:149], s[60:61]
    v_pk_mul_f32 v[150:151], v[150:151], s[60:61]
    v_cvt_pk_bf16_f32 v170, v148, v149
    v_cvt_pk_bf16_f32 v171, v150, v151
    buffer_store_dwordx4 v[168:171], v232, s[28:31], s63 offen sc1
    s_waitcnt lgkmcnt(0)
    s_barrier
    ds_read_b128 v[92:95], v9 offset:0
    ds_read_b128 v[96:99], v9 offset:2048
    ds_read_b64_tr_b16 v[32:33], v8 offset:0
    ds_read_b64_tr_b16 v[34:35], v8 offset:2560
    ds_read_b64_tr_b16 v[36:37], v8 offset:8
    ds_read_b64_tr_b16 v[38:39], v8 offset:2568
    ds_read_b64_tr_b16 v[40:41], v8 offset:16
    ds_read_b64_tr_b16 v[42:43], v8 offset:2576
    ds_read_b64_tr_b16 v[44:45], v8 offset:24
    ds_read_b64_tr_b16 v[46:47], v8 offset:2584
    ds_read_b128 v[100:103], v10 offset:0
    ds_read_b128 v[104:107], v10 offset:2048
    ds_read_b64_tr_b16 v[48:49], v8 offset:32
    ds_read_b64_tr_b16 v[50:51], v8 offset:2592
    ds_read_b64_tr_b16 v[52:53], v8 offset:5120
    ds_read_b64_tr_b16 v[54:55], v8 offset:7680
    ds_read_b64_tr_b16 v[56:57], v8 offset:5128
    ds_read_b64_tr_b16 v[58:59], v8 offset:7688
    s_waitcnt lgkmcnt(12)
    v_mfma_f32_16x16x32_bf16 v[192:195], v[32:35], v[92:95], v[192:195]
    ds_read_b64_tr_b16 v[60:61], v8 offset:5136
    v_mfma_f32_16x16x32_bf16 v[196:199], v[32:35], v[96:99], v[196:199]
    ds_read_b64_tr_b16 v[62:63], v8 offset:7696
    v_mfma_f32_16x16x32_bf16 v[200:203], v[36:39], v[92:95], v[200:203]
    ds_read_b64_tr_b16 v[64:65], v8 offset:5144
    v_mfma_f32_16x16x32_bf16 v[204:207], v[36:39], v[96:99], v[204:207]
    ds_read_b64_tr_b16 v[66:67], v8 offset:7704
    s_waitcnt lgkmcnt(12)
    v_mfma_f32_16x16x32_bf16 v[208:211], v[40:43], v[92:95], v[208:211]
    ds_read_b64_tr_b16 v[68:69], v8 offset:5152
    v_mfma_f32_16x16x32_bf16 v[212:215], v[40:43], v[96:99], v[212:215]
    ds_read_b64_tr_b16 v[70:71], v8 offset:7712
    v_mfma_f32_16x16x32_bf16 v[216:219], v[44:47], v[92:95], v[216:219]
    v_add_u32 v8, 47104, v8
    ds_read_b64_tr_b16 v[72:73], v8 offset:0
    v_mfma_f32_16x16x32_bf16 v[220:223], v[44:47], v[96:99], v[220:223]
    ds_read_b64_tr_b16 v[74:75], v8 offset:2560
    s_waitcnt lgkmcnt(10)
    v_mfma_f32_16x16x32_bf16 v[224:227], v[48:51], v[92:95], v[224:227]
    ds_read_b64_tr_b16 v[76:77], v8 offset:8
    v_mfma_f32_16x16x32_bf16 v[228:231], v[48:51], v[96:99], v[228:231]
    ds_read_b64_tr_b16 v[78:79], v8 offset:2568
    v_mfma_f32_16x16x32_bf16 v[192:195], v[52:55], v[100:103], v[192:195]
    ds_read_b64_tr_b16 v[80:81], v8 offset:16
    ds_read_b64_tr_b16 v[82:83], v8 offset:2576
    v_add_u32 v9, 47104, v9
    v_mfma_f32_16x16x32_bf16 v[196:199], v[52:55], v[104:107], v[196:199]
    ds_read_b128 v[92:95], v9 offset:0
    ds_read_b128 v[96:99], v9 offset:2048
    s_waitcnt lgkmcnt(12)
    v_mfma_f32_16x16x32_bf16 v[200:203], v[56:59], v[100:103], v[200:203]
    ds_read_b64_tr_b16 v[84:85], v8 offset:24
    v_mfma_f32_16x16x32_bf16 v[204:207], v[56:59], v[104:107], v[204:207]
    ds_read_b64_tr_b16 v[86:87], v8 offset:2584
    v_mfma_f32_16x16x32_bf16 v[208:211], v[60:63], v[100:103], v[208:211]
    ds_read_b64_tr_b16 v[88:89], v8 offset:32
    v_mfma_f32_16x16x32_bf16 v[212:215], v[60:63], v[104:107], v[212:215]
    ds_read_b64_tr_b16 v[90:91], v8 offset:2592
    s_waitcnt lgkmcnt(12)
    v_mfma_f32_16x16x32_bf16 v[216:219], v[64:67], v[100:103], v[216:219]
    ds_read_b64_tr_b16 v[32:33], v8 offset:5120
    v_mfma_f32_16x16x32_bf16 v[220:223], v[64:67], v[104:107], v[220:223]
    ds_read_b64_tr_b16 v[34:35], v8 offset:7680
    v_mfma_f32_16x16x32_bf16 v[224:227], v[68:71], v[100:103], v[224:227]
    ds_read_b64_tr_b16 v[36:37], v8 offset:5128
    v_mfma_f32_16x16x32_bf16 v[228:231], v[68:71], v[104:107], v[228:231]
    ds_read_b64_tr_b16 v[38:39], v8 offset:7688
    s_waitcnt lgkmcnt(8)
    v_mfma_f32_16x16x32_bf16 v[192:195], v[72:75], v[92:95], v[192:195]
    ds_read_b64_tr_b16 v[40:41], v8 offset:5136
    ds_read_b64_tr_b16 v[42:43], v8 offset:7696
    v_add_u32 v10, 47104, v10
    v_mfma_f32_16x16x32_bf16 v[196:199], v[72:75], v[96:99], v[196:199]
    ds_read_b128 v[100:103], v10 offset:0
    ds_read_b128 v[104:107], v10 offset:2048
    v_mfma_f32_16x16x32_bf16 v[200:203], v[76:79], v[92:95], v[200:203]
    ds_read_b64_tr_b16 v[44:45], v8 offset:5144
    v_mfma_f32_16x16x32_bf16 v[204:207], v[76:79], v[96:99], v[204:207]
    ds_read_b64_tr_b16 v[46:47], v8 offset:7704
    s_waitcnt lgkmcnt(12)
    v_mfma_f32_16x16x32_bf16 v[208:211], v[80:83], v[92:95], v[208:211]
    ds_read_b64_tr_b16 v[48:49], v8 offset:5152
    v_mfma_f32_16x16x32_bf16 v[212:215], v[80:83], v[96:99], v[212:215]
    ds_read_b64_tr_b16 v[50:51], v8 offset:7712
    v_mfma_f32_16x16x32_bf16 v[216:219], v[84:87], v[92:95], v[216:219]
    v_add_u32 v8, 47104, v8
    ds_read_b64_tr_b16 v[52:53], v8 offset:0
    v_mfma_f32_16x16x32_bf16 v[220:223], v[84:87], v[96:99], v[220:223]
    ds_read_b64_tr_b16 v[54:55], v8 offset:2560
    s_waitcnt lgkmcnt(6)
    v_mfma_f32_16x16x32_bf16 v[224:227], v[88:91], v[92:95], v[224:227]
    ds_read_b64_tr_b16 v[56:57], v8 offset:8
    v_mfma_f32_16x16x32_bf16 v[228:231], v[88:91], v[96:99], v[228:231]
    ds_read_b64_tr_b16 v[58:59], v8 offset:2568
    v_mfma_f32_16x16x32_bf16 v[192:195], v[32:35], v[100:103], v[192:195]
    ds_read_b64_tr_b16 v[60:61], v8 offset:16
    ds_read_b64_tr_b16 v[62:63], v8 offset:2576
    v_add_u32 v9, 47104, v9
    v_mfma_f32_16x16x32_bf16 v[196:199], v[32:35], v[104:107], v[196:199]
    ds_read_b128 v[92:95], v9 offset:0
    ds_read_b128 v[96:99], v9 offset:2048
    v_mfma_f32_16x16x32_bf16 v[200:203], v[36:39], v[100:103], v[200:203]
    ds_read_b64_tr_b16 v[64:65], v8 offset:24
    v_mfma_f32_16x16x32_bf16 v[204:207], v[36:39], v[104:107], v[204:207]
    ds_read_b64_tr_b16 v[66:67], v8 offset:2584
    v_mfma_f32_16x16x32_bf16 v[208:211], v[40:43], v[100:103], v[208:211]
    ds_read_b64_tr_b16 v[68:69], v8 offset:32
    v_mfma_f32_16x16x32_bf16 v[212:215], v[40:43], v[104:107], v[212:215]
    ds_read_b64_tr_b16 v[70:71], v8 offset:2592
    s_waitcnt lgkmcnt(12)
    s_waitcnt vmcnt(0)
    s_barrier
    v_mfma_f32_16x16x32_bf16 v[216:219], v[44:47], v[100:103], v[216:219]
    ds_read_b64_tr_b16 v[72:73], v8 offset:5120
    v_mfma_f32_16x16x32_bf16 v[220:223], v[44:47], v[104:107], v[220:223]
    ds_read_b64_tr_b16 v[74:75], v8 offset:7680
    v_mfma_f32_16x16x32_bf16 v[224:227], v[48:51], v[100:103], v[224:227]
    ds_read_b64_tr_b16 v[76:77], v8 offset:5128
    ds_read_b64_tr_b16 v[16:17], v237 offset:0
    ds_read_b64_tr_b16 v[18:19], v237 offset:160
    v_mfma_f32_16x16x32_bf16 v[228:231], v[48:51], v[104:107], v[228:231]
    ds_read_b64_tr_b16 v[78:79], v8 offset:7688
    ds_read_b64_tr_b16 v[20:21], v237 offset:320
    ds_read_b64_tr_b16 v[22:23], v237 offset:480
    s_waitcnt lgkmcnt(12)
    v_mfma_f32_16x16x32_bf16 v[192:195], v[52:55], v[92:95], v[192:195]
    ds_read_b64_tr_b16 v[80:81], v8 offset:5136
    ds_read_b64_tr_b16 v[82:83], v8 offset:7696
    v_add_u32 v10, 47104, v10
    ds_read_b64_tr_b16 v[24:25], v237 offset:640
    ds_read_b64_tr_b16 v[26:27], v237 offset:8
    v_mfma_f32_16x16x32_bf16 v[196:199], v[52:55], v[96:99], v[196:199]
    ds_read_b128 v[100:103], v10 offset:0
    ds_read_b128 v[104:107], v10 offset:2048
    ds_read_b64_tr_b16 v[28:29], v237 offset:168
    ds_read_b64_tr_b16 v[30:31], v237 offset:328
    v_mfma_f32_16x16x32_bf16 v[200:203], v[56:59], v[92:95], v[200:203]
    ds_read_b64_tr_b16 v[84:85], v8 offset:5144
    ds_read_b64_tr_b16 v[32:33], v237 offset:488
    ds_read_b64_tr_b16 v[34:35], v237 offset:648
    v_mfma_f32_16x16x32_bf16 v[204:207], v[56:59], v[96:99], v[204:207]
    ds_read_b64_tr_b16 v[86:87], v8 offset:7704
    ds_read_b64_tr_b16 v[36:37], v237 offset:16
    ds_read_b64_tr_b16 v[38:39], v237 offset:176
    s_waitcnt lgkmcnt(15)
    v_mfma_f32_16x16x32_bf16 v[208:211], v[60:63], v[92:95], v[208:211]
    ds_read_b64_tr_b16 v[88:89], v8 offset:5152
    ds_read_b64_tr_b16 v[40:41], v237 offset:336
    ds_read_b64_tr_b16 v[42:43], v237 offset:496
    v_mfma_f32_16x16x32_bf16 v[212:215], v[60:63], v[96:99], v[212:215]
    ds_read_b64_tr_b16 v[90:91], v8 offset:7712
    ds_read_b64_tr_b16 v[44:45], v237 offset:656
    ds_read_b64_tr_b16 v[46:47], v237 offset:24
    v_mfma_f32_16x16x32_bf16 v[216:219], v[64:67], v[92:95], v[216:219]
    ds_read_b64_tr_b16 v[48:49], v237 offset:184
    ds_read_b64_tr_b16 v[50:51], v237 offset:344
    v_mfma_f32_16x16x32_bf16 v[220:223], v[64:67], v[96:99], v[220:223]
    ds_read_b64_tr_b16 v[52:53], v237 offset:504
    ds_read_b64_tr_b16 v[54:55], v237 offset:664
    s_waitcnt lgkmcnt(15)
    v_mfma_f32_16x16x32_bf16 v[224:227], v[68:71], v[92:95], v[224:227]
    ds_read_b64_tr_b16 v[56:57], v237 offset:32
    ds_read_b64_tr_b16 v[58:59], v237 offset:192
    v_mfma_f32_16x16x32_bf16 v[228:231], v[68:71], v[96:99], v[228:231]
    ds_read_b64_tr_b16 v[60:61], v237 offset:352
    ds_read_b64_tr_b16 v[62:63], v237 offset:512
    v_mfma_f32_16x16x32_bf16 v[192:195], v[72:75], v[100:103], v[192:195]
    ds_read_b64_tr_b16 v[64:65], v237 offset:672
    v_mfma_f32_16x16x32_bf16 v[196:199], v[72:75], v[104:107], v[196:199]
    v_mfma_f32_16x16x32_bf16 v[200:203], v[76:79], v[100:103], v[200:203]
    v_mfma_f32_16x16x32_bf16 v[204:207], v[76:79], v[104:107], v[204:207]
    v_mfma_f32_16x16x32_bf16 v[208:211], v[80:83], v[100:103], v[208:211]
    v_mfma_f32_16x16x32_bf16 v[212:215], v[80:83], v[104:107], v[212:215]
    s_waitcnt lgkmcnt(11)
    v_mfma_f32_16x16x32_bf16 v[216:219], v[84:87], v[100:103], v[216:219]
    v_mfma_f32_16x16x32_bf16 v[220:223], v[84:87], v[104:107], v[220:223]
    v_mfma_f32_16x16x32_bf16 v[224:227], v[88:91], v[100:103], v[224:227]
    v_mfma_f32_16x16x32_bf16 v[228:231], v[88:91], v[104:107], v[228:231]
    v_mov_b32 v8, 163824
    v_cvt_pk_bf16_f32 v112, v192, v193
    v_cvt_pk_bf16_f32 v113, v194, v195
    v_cvt_pk_bf16_f32 v114, v200, v201
    v_cvt_pk_bf16_f32 v115, v202, v203
    v_cvt_pk_bf16_f32 v116, v208, v209
    v_cvt_pk_bf16_f32 v117, v210, v211
    v_cvt_pk_bf16_f32 v118, v216, v217
    v_cvt_pk_bf16_f32 v119, v218, v219
    v_cvt_pk_bf16_f32 v120, v224, v225
    v_cvt_pk_bf16_f32 v121, v226, v227
    v_mov_b64 v[122:123], 0
    v_cvt_pk_bf16_f32 v124, v196, v197
    v_cvt_pk_bf16_f32 v125, v198, v199
    v_cvt_pk_bf16_f32 v126, v204, v205
    v_cvt_pk_bf16_f32 v127, v206, v207
    v_cvt_pk_bf16_f32 v128, v212, v213
    v_cvt_pk_bf16_f32 v129, v214, v215
    v_cvt_pk_bf16_f32 v130, v220, v221
    v_cvt_pk_bf16_f32 v131, v222, v223
    v_cvt_pk_bf16_f32 v132, v228, v229
    v_cvt_pk_bf16_f32 v133, v230, v231
    v_mov_b64 v[134:135], 0
    s_waitcnt lgkmcnt(0)
    v_mfma_f32_16x16x32_bf16 v[198:201], v[16:19], v[112:115], 0
    v_mov_b64 v[66:67], 0
    v_mfma_f32_16x16x32_bf16 v[202:205], v[26:29], v[112:115], 0
    v_mfma_f32_16x16x32_bf16 v[206:209], v[36:39], v[112:115], 0
    v_mfma_f32_16x16x32_bf16 v[210:213], v[46:49], v[112:115], 0
    v_mfma_f32_16x16x32_bf16 v[214:217], v[56:59], v[112:115], 0
    v_mfma_f32_16x16x32_bf16 v[198:201], v[20:23], v[116:119], v[198:201]
    v_mfma_f32_16x16x32_bf16 v[202:205], v[30:33], v[116:119], v[202:205]
    v_mfma_f32_16x16x32_bf16 v[206:209], v[40:43], v[116:119], v[206:209]
    v_mfma_f32_16x16x32_bf16 v[210:213], v[50:53], v[116:119], v[210:213]
    v_mfma_f32_16x16x32_bf16 v[214:217], v[60:63], v[116:119], v[214:217]
    v_mfma_f32_16x16x32_bf16 v[198:201], v[24:27], v[120:123], v[198:201]
    v_mfma_f32_16x16x32_bf16 v[202:205], v[34:37], v[120:123], v[202:205]
    v_mfma_f32_16x16x32_bf16 v[206:209], v[44:47], v[120:123], v[206:209]
    v_mfma_f32_16x16x32_bf16 v[210:213], v[54:57], v[120:123], v[210:213]
    v_mfma_f32_16x16x32_bf16 v[214:217], v[64:67], v[120:123], v[214:217]
    v_mfma_f32_16x16x32_bf16 v[172:175], v[16:19], v[124:127], 0
    v_mfma_f32_16x16x32_bf16 v[176:179], v[26:29], v[124:127], 0
    s_nop 0
    v_mfma_f32_16x16x32_bf16 v[180:183], v[36:39], v[124:127], 0
    v_mul_f32 v198, s52, v198
    v_mul_f32 v199, s52, v199
    v_mfma_f32_16x16x32_bf16 v[184:187], v[46:49], v[124:127], 0
    v_mul_f32 v200, s52, v200
    v_mul_f32 v201, s52, v201
    v_mfma_f32_16x16x32_bf16 v[188:191], v[56:59], v[124:127], 0
    v_mul_f32 v202, s52, v202
    v_mul_f32 v203, s52, v203
    v_mfma_f32_16x16x32_bf16 v[172:175], v[20:23], v[128:131], v[172:175]
    v_mul_f32 v204, s52, v204
    v_mul_f32 v205, s52, v205
    v_mfma_f32_16x16x32_bf16 v[176:179], v[30:33], v[128:131], v[176:179]
    v_mul_f32 v206, s52, v206
    v_mul_f32 v207, s52, v207
    v_mfma_f32_16x16x32_bf16 v[180:183], v[40:43], v[128:131], v[180:183]
    v_mul_f32 v208, s52, v208
    v_mul_f32 v209, s52, v209
    v_mfma_f32_16x16x32_bf16 v[184:187], v[50:53], v[128:131], v[184:187]
    v_mul_f32 v210, s52, v210
    v_mul_f32 v211, s52, v211
    v_mfma_f32_16x16x32_bf16 v[188:191], v[60:63], v[128:131], v[188:191]
    v_mul_f32 v212, s52, v212
    v_mul_f32 v213, s52, v213
    v_mfma_f32_16x16x32_bf16 v[172:175], v[24:27], v[132:135], v[172:175]
    v_mul_f32 v214, s52, v214
    v_mul_f32 v215, s52, v215
    v_mfma_f32_16x16x32_bf16 v[176:179], v[34:37], v[132:135], v[176:179]
    v_mul_f32 v216, s52, v216
    v_mul_f32 v217, s52, v217
    v_mfma_f32_16x16x32_bf16 v[180:183], v[44:47], v[132:135], v[180:183]
    v_max3_f32 v11, abs(v198), abs(v199), abs(v200)
    v_max3_f32 v12, abs(v201), abs(v202), abs(v203)
    v_mfma_f32_16x16x32_bf16 v[184:187], v[54:57], v[132:135], v[184:187]
    v_max3_f32 v12, abs(v204), abs(v205), v12
    v_max3_f32 v11, abs(v206), abs(v207), v11
    v_mfma_f32_16x16x32_bf16 v[188:191], v[64:67], v[132:135], v[188:191]
    v_max3_f32 v12, abs(v208), abs(v209), v12
    v_max3_f32 v11, abs(v210), abs(v211), v11
    v_max3_f32 v12, abs(v212), abs(v213), v12
    v_max3_f32 v11, abs(v214), abs(v215), v11
    v_max3_f32 v12, abs(v216), abs(v217), v12
    v_max_f32 v11, v11, v12
    v_exp_f32 v132, v198
    v_exp_f32 v133, v199
    v_exp_f32 v134, v200
    v_exp_f32 v135, v201
    v_exp_f32 v136, v202
    v_exp_f32 v137, v203
    v_exp_f32 v138, v204
    v_exp_f32 v139, v205
    v_exp_f32 v140, v206
    v_exp_f32 v141, v207
    v_exp_f32 v142, v208
    v_exp_f32 v143, v209
    v_exp_f32 v144, v210
    v_exp_f32 v145, v211
    v_exp_f32 v146, v212
    v_exp_f32 v147, v213
    v_exp_f32 v148, v214
    v_exp_f32 v149, v215
    v_exp_f32 v150, v216
    v_exp_f32 v151, v217
    v_exp_f32 v112, -v198
    v_exp_f32 v113, -v199
    v_exp_f32 v114, -v200
    v_exp_f32 v115, -v201
    v_exp_f32 v116, -v202
    v_exp_f32 v117, -v203
    v_exp_f32 v118, -v204
    v_exp_f32 v119, -v205
    v_exp_f32 v120, -v206
    v_exp_f32 v121, -v207
    v_exp_f32 v122, -v208
    v_exp_f32 v123, -v209
    v_exp_f32 v124, -v210
    v_exp_f32 v125, -v211
    v_exp_f32 v126, -v212
    v_exp_f32 v127, -v213
    v_exp_f32 v128, -v214
    v_cmp_lt_f32 vcc, 1119879168, v11
    v_exp_f32 v129, -v215
    v_exp_f32 v130, -v216
    v_exp_f32 v131, -v217
    s_cbranch_vccnz L_psb0
L_prb0:
    v_pk_add_f32 v[16:17], v[132:133], v[134:135]
    v_pk_add_f32 v[18:19], v[112:113], v[114:115]
    v_pk_add_f32 v[16:17], v[16:17], v[136:137]
    v_pk_add_f32 v[18:19], v[18:19], v[116:117]
    v_pk_add_f32 v[16:17], v[16:17], v[138:139]
    v_pk_add_f32 v[18:19], v[18:19], v[118:119]
    v_pk_add_f32 v[16:17], v[16:17], v[140:141]
    v_pk_add_f32 v[18:19], v[18:19], v[120:121]
    v_pk_add_f32 v[16:17], v[16:17], v[142:143]
    v_pk_add_f32 v[18:19], v[18:19], v[122:123]
    v_pk_add_f32 v[16:17], v[16:17], v[144:145]
    v_pk_add_f32 v[18:19], v[18:19], v[124:125]
    v_pk_add_f32 v[16:17], v[16:17], v[146:147]
    v_pk_add_f32 v[18:19], v[18:19], v[126:127]
    v_pk_add_f32 v[16:17], v[16:17], v[148:149]
    v_pk_add_f32 v[18:19], v[18:19], v[128:129]
    v_pk_add_f32 v[16:17], v[16:17], v[150:151]
    v_pk_add_f32 v[18:19], v[18:19], v[130:131]
    v_add_f32 v16, v16, v17
    v_add_f32 v18, v18, v19
    v_rcp_f32 v16, v16
    v_rcp_f32 v18, v18
    v_pk_mul_f32 v[132:133], v[132:133], v[16:17] op_sel_hi:[1,0]
    v_pk_mul_f32 v[134:135], v[134:135], v[16:17] op_sel_hi:[1,0]
    v_pk_mul_f32 v[136:137], v[136:137], v[16:17] op_sel_hi:[1,0]
    v_pk_mul_f32 v[138:139], v[138:139], v[16:17] op_sel_hi:[1,0]
    v_cvt_pk_bf16_f32 v198, v132, v133
    v_cvt_pk_bf16_f32 v199, v134, v135
    v_cvt_pk_bf16_f32 v200, v136, v137
    v_cvt_pk_bf16_f32 v201, v138, v139
    v_pk_mul_f32 v[140:141], v[140:141], v[16:17] op_sel_hi:[1,0]
    v_pk_mul_f32 v[142:143], v[142:143], v[16:17] op_sel_hi:[1,0]
    v_pk_mul_f32 v[144:145], v[144:145], v[16:17] op_sel_hi:[1,0]
    v_pk_mul_f32 v[146:147], v[146:147], v[16:17] op_sel_hi:[1,0]
    v_cvt_pk_bf16_f32 v202, v140, v141
    v_cvt_pk_bf16_f32 v203, v142, v143
    v_cvt_pk_bf16_f32 v204, v144, v145
    v_cvt_pk_bf16_f32 v205, v146, v147
    v_pk_mul_f32 v[148:149], v[148:149], v[16:17] op_sel_hi:[1,0]
    v_pk_mul_f32 v[150:151], v[150:151], v[16:17] op_sel_hi:[1,0]
    v_pk_mul_f32 v[112:113], v[112:113], v[18:19] op_sel_hi:[1,0]
    v_pk_mul_f32 v[114:115], v[114:115], v[18:19] op_sel_hi:[1,0]
    v_cvt_pk_bf16_f32 v206, v148, v149
    v_cvt_pk_bf16_f32 v207, v150, v151
    v_cvt_pk_bf16_f32 v208, v112, v113
    v_cvt_pk_bf16_f32 v209, v114, v115
    v_pk_mul_f32 v[116:117], v[116:117], v[18:19] op_sel_hi:[1,0]
    v_pk_mul_f32 v[118:119], v[118:119], v[18:19] op_sel_hi:[1,0]
    v_pk_mul_f32 v[120:121], v[120:121], v[18:19] op_sel_hi:[1,0]
    v_pk_mul_f32 v[122:123], v[122:123], v[18:19] op_sel_hi:[1,0]
    v_cvt_pk_bf16_f32 v210, v116, v117
    v_cvt_pk_bf16_f32 v211, v118, v119
    v_cvt_pk_bf16_f32 v212, v120, v121
    v_cvt_pk_bf16_f32 v213, v122, v123
    v_pk_mul_f32 v[124:125], v[124:125], v[18:19] op_sel_hi:[1,0]
    v_pk_mul_f32 v[126:127], v[126:127], v[18:19] op_sel_hi:[1,0]
    v_pk_mul_f32 v[128:129], v[128:129], v[18:19] op_sel_hi:[1,0]
    v_pk_mul_f32 v[130:131], v[130:131], v[18:19] op_sel_hi:[1,0]
    v_cvt_pk_bf16_f32 v214, v124, v125
    v_cvt_pk_bf16_f32 v215, v126, v127
    v_cvt_pk_bf16_f32 v216, v128, v129
    v_cvt_pk_bf16_f32 v217, v130, v131
    v_pk_mul_f32 v[172:173], v[172:173], s[52:53]
    v_pk_mul_f32 v[174:175], v[174:175], s[52:53]
    v_pk_mul_f32 v[176:177], v[176:177], s[52:53]
    v_pk_mul_f32 v[178:179], v[178:179], s[52:53]
    v_pk_mul_f32 v[180:181], v[180:181], s[52:53]
    v_pk_mul_f32 v[182:183], v[182:183], s[52:53]
    v_pk_mul_f32 v[184:185], v[184:185], s[52:53]
    v_pk_mul_f32 v[186:187], v[186:187], s[52:53]
    v_pk_mul_f32 v[188:189], v[188:189], s[52:53]
    v_pk_mul_f32 v[190:191], v[190:191], s[52:53]
    v_max3_f32 v11, abs(v172), abs(v173), abs(v174)
    v_max3_f32 v12, abs(v175), abs(v176), abs(v177)
    v_max3_f32 v12, abs(v178), abs(v179), v12
    v_max3_f32 v11, abs(v180), abs(v181), v11
    v_max3_f32 v12, abs(v182), abs(v183), v12
    v_max3_f32 v11, abs(v184), abs(v185), v11
    v_max3_f32 v12, abs(v186), abs(v187), v12
    v_max3_f32 v11, abs(v188), abs(v189), v11
    v_max3_f32 v12, abs(v190), abs(v191), v12
    v_max_f32 v11, v11, v12
    v_exp_f32 v132, v172
    v_exp_f32 v133, v173
    v_exp_f32 v134, v174
    v_exp_f32 v135, v175
    v_exp_f32 v136, v176
    v_exp_f32 v137, v177
    v_exp_f32 v138, v178
    v_exp_f32 v139, v179
    v_exp_f32 v140, v180
    v_exp_f32 v141, v181
    v_exp_f32 v142, v182
    v_exp_f32 v143, v183
    v_exp_f32 v144, v184
    v_exp_f32 v145, v185
    v_exp_f32 v146, v186
    v_exp_f32 v147, v187
    v_exp_f32 v148, v188
    v_exp_f32 v149, v189
    v_exp_f32 v150, v190
    v_exp_f32 v151, v191
    v_exp_f32 v112, -v172
    v_exp_f32 v113, -v173
    v_exp_f32 v114, -v174
    v_exp_f32 v115, -v175
    v_exp_f32 v116, -v176
    v_exp_f32 v117, -v177
    v_exp_f32 v118, -v178
    v_exp_f32 v119, -v179
    v_exp_f32 v120, -v180
    v_exp_f32 v121, -v181
    v_exp_f32 v122, -v182
    v_exp_f32 v123, -v183
    v_exp_f32 v124, -v184
    v_exp_f32 v125, -v185
    v_exp_f32 v126, -v186
    v_exp_f32 v127, -v187
    v_exp_f32 v128, -v188
    v_cmp_lt_f32 vcc, 1119879168, v11
    v_exp_f32 v129, -v189
    v_exp_f32 v130, -v190
    v_exp_f32 v131, -v191
    s_cbranch_vccnz L_psb1
L_prb1:
    v_pk_add_f32 v[16:17], v[132:133], v[134:135]
    v_pk_add_f32 v[18:19], v[112:113], v[114:115]
    v_pk_add_f32 v[16:17], v[16:17], v[136:137]
    v_pk_add_f32 v[18:19], v[18:19], v[116:117]
    v_pk_add_f32 v[16:17], v[16:17], v[138:139]
    v_pk_add_f32 v[18:19], v[18:19], v[118:119]
    v_pk_add_f32 v[16:17], v[16:17], v[140:141]
    v_pk_add_f32 v[18:19], v[18:19], v[120:121]
    v_pk_add_f32 v[16:17], v[16:17], v[142:143]
    v_pk_add_f32 v[18:19], v[18:19], v[122:123]
    v_pk_add_f32 v[16:17], v[16:17], v[144:145]
    v_pk_add_f32 v[18:19], v[18:19], v[124:125]
    v_pk_add_f32 v[16:17], v[16:17], v[146:147]
    v_pk_add_f32 v[18:19], v[18:19], v[126:127]
    v_pk_add_f32 v[16:17], v[16:17], v[148:149]
    v_pk_add_f32 v[18:19], v[18:19], v[128:129]
    v_pk_add_f32 v[16:17], v[16:17], v[150:151]
    v_pk_add_f32 v[18:19], v[18:19], v[130:131]
    v_add_f32 v16, v16, v17
    v_add_f32 v18, v18, v19
    v_rcp_f32 v16, v16
    v_rcp_f32 v18, v18
    v_pk_mul_f32 v[132:133], v[132:133], v[16:17] op_sel_hi:[1,0]
    v_pk_mul_f32 v[134:135], v[134:135], v[16:17] op_sel_hi:[1,0]
    v_pk_mul_f32 v[136:137], v[136:137], v[16:17] op_sel_hi:[1,0]
    v_pk_mul_f32 v[138:139], v[138:139], v[16:17] op_sel_hi:[1,0]
    v_cvt_pk_bf16_f32 v218, v132, v133
    v_cvt_pk_bf16_f32 v219, v134, v135
    v_cvt_pk_bf16_f32 v220, v136, v137
    v_cvt_pk_bf16_f32 v221, v138, v139
    v_pk_mul_f32 v[140:141], v[140:141], v[16:17] op_sel_hi:[1,0]
    v_pk_mul_f32 v[142:143], v[142:143], v[16:17] op_sel_hi:[1,0]
    v_pk_mul_f32 v[144:145], v[144:145], v[16:17] op_sel_hi:[1,0]
    v_pk_mul_f32 v[146:147], v[146:147], v[16:17] op_sel_hi:[1,0]
    v_cvt_pk_bf16_f32 v222, v140, v141
    v_cvt_pk_bf16_f32 v223, v142, v143
    v_cvt_pk_bf16_f32 v224, v144, v145
    v_cvt_pk_bf16_f32 v225, v146, v147
    v_pk_mul_f32 v[148:149], v[148:149], v[16:17] op_sel_hi:[1,0]
    v_pk_mul_f32 v[150:151], v[150:151], v[16:17] op_sel_hi:[1,0]
    v_pk_mul_f32 v[112:113], v[112:113], v[18:19] op_sel_hi:[1,0]
    v_pk_mul_f32 v[114:115], v[114:115], v[18:19] op_sel_hi:[1,0]
    v_cvt_pk_bf16_f32 v226, v148, v149
    v_cvt_pk_bf16_f32 v227, v150, v151
    v_cvt_pk_bf16_f32 v228, v112, v113
    v_cvt_pk_bf16_f32 v229, v114, v115
    v_pk_mul_f32 v[116:117], v[116:117], v[18:19] op_sel_hi:[1,0]
    v_pk_mul_f32 v[118:119], v[118:119], v[18:19] op_sel_hi:[1,0]
    v_pk_mul_f32 v[120:121], v[120:121], v[18:19] op_sel_hi:[1,0]
    v_pk_mul_f32 v[122:123], v[122:123], v[18:19] op_sel_hi:[1,0]
    v_cvt_pk_bf16_f32 v230, v116, v117
    v_cvt_pk_bf16_f32 v231, v118, v119
    v_cvt_pk_bf16_f32 v232, v120, v121
    v_cvt_pk_bf16_f32 v233, v122, v123
    v_pk_mul_f32 v[124:125], v[124:125], v[18:19] op_sel_hi:[1,0]
    v_pk_mul_f32 v[126:127], v[126:127], v[18:19] op_sel_hi:[1,0]
    v_pk_mul_f32 v[128:129], v[128:129], v[18:19] op_sel_hi:[1,0]
    v_pk_mul_f32 v[130:131], v[130:131], v[18:19] op_sel_hi:[1,0]
    v_cvt_pk_bf16_f32 v234, v124, v125
    v_cvt_pk_bf16_f32 v235, v126, v127
    v_cvt_pk_bf16_f32 v236, v128, v129
    v_cvt_pk_bf16_f32 v237, v130, v131
    s_branch L_b13
L_lphi:
    v_bfe_u32 v12, v1, 2, 2
    v_mul_u32_u24 v12, 40, v12
    v_mul_u32_u24 v13, 800, v4
    v_add_u32 v12, v12, v13
    v_and_b32 v13, 3, v1
    v_cmp_eq_u32 vcc, v13, v4
    v_mov_b32 v13, 3200
    s_nop 0
    v_cndmask_b32 v12, v13, v12, vcc
    v_add_u32 v237, 141312, v12
    v_mul_u32_u24 v11, 352, v3
    v_and_b32 v16, 4, v3
    v_lshl_add_u32 v11, v16, 2, v11
    v_and_b32 v16, 8, v3
    v_lshl_add_u32 v11, v16, 4, v11
    v_mul_u32_u24 v12, 80, v4
    v_add_u32 v11, v11, v12
    s_lshr_b32 s50, s36, 1
    s_mul_i32 s50, s50, 47104
    s_and_b32 s51, s36, 1
    s_mul_i32 s51, s51, 20480
    s_add_u32 s50, s50, s51
    s_add_u32 s50, s50, 47104
    v_add_u32 v234, s50, v11
    s_add_u32 s50, s50, 5760
    v_add_u32 v13, s50, v2
    ds_read_b64_tr_b16 v[16:17], v237 offset:0
    ds_read_b64_tr_b16 v[18:19], v237 offset:160
    ds_read_b64_tr_b16 v[20:21], v237 offset:320
    ds_read_b64_tr_b16 v[22:23], v237 offset:480
    ds_read_b64_tr_b16 v[24:25], v237 offset:640
    ds_read_b64_tr_b16 v[26:27], v237 offset:8
    ds_read_b64_tr_b16 v[28:29], v237 offset:168
    ds_read_b64_tr_b16 v[30:31], v237 offset:328
    ds_read_b64_tr_b16 v[32:33], v237 offset:488
    ds_read_b64_tr_b16 v[34:35], v237 offset:648
    ds_read_b64_tr_b16 v[36:37], v237 offset:16
    ds_read_b64_tr_b16 v[38:39], v237 offset:176
    ds_read_b64_tr_b16 v[40:41], v237 offset:336
    ds_read_b64_tr_b16 v[42:43], v237 offset:496
    ds_read_b64_tr_b16 v[44:45], v237 offset:656
    ds_read_b64_tr_b16 v[46:47], v237 offset:24
    ds_read_b64_tr_b16 v[48:49], v237 offset:184
    ds_read_b64_tr_b16 v[50:51], v237 offset:344
    ds_read_b64_tr_b16 v[52:53], v237 offset:504
    ds_read_b64_tr_b16 v[54:55], v237 offset:664
    ds_read_b64_tr_b16 v[56:57], v237 offset:32
    ds_read_b64_tr_b16 v[58:59], v237 offset:192
    ds_read_b64_tr_b16 v[60:61], v237 offset:352
    ds_read_b64_tr_b16 v[62:63], v237 offset:512
    ds_read_b64_tr_b16 v[64:65], v237 offset:672
    s_mov_b32 s47, 1069066811
    v_mov_b64 v[134:135], 0
    v_mov_b32 v8, 163824
    v_mov_b32 v10, 1
    s_waitcnt vmcnt(0)
    s_barrier
    ds_read_b128 v[124:127], v13
    ds_read_b128 v[128:131], v13 offset:1024
    ds_read_b64 v[132:133], v13 offset:2048
    s_setprio 1
    s_waitcnt lgkmcnt(0)
    v_mfma_f32_16x16x32_bf16 v[212:215], v[16:19], v[124:127], 0
    v_mov_b64 v[66:67], 0
    v_mfma_f32_16x16x32_bf16 v[216:219], v[26:29], v[124:127], 0
    v_mfma_f32_16x16x32_bf16 v[220:223], v[36:39], v[124:127], 0
    v_mfma_f32_16x16x32_bf16 v[224:227], v[46:49], v[124:127], 0
    v_mfma_f32_16x16x32_bf16 v[228:231], v[56:59], v[124:127], 0
    v_mfma_f32_16x16x32_bf16 v[212:215], v[20:23], v[128:131], v[212:215]
    v_mfma_f32_16x16x32_bf16 v[216:219], v[30:33], v[128:131], v[216:219]
    v_mfma_f32_16x16x32_bf16 v[220:223], v[40:43], v[128:131], v[220:223]
    v_mfma_f32_16x16x32_bf16 v[224:227], v[50:53], v[128:131], v[224:227]
    v_mfma_f32_16x16x32_bf16 v[228:231], v[60:63], v[128:131], v[228:231]
    v_mfma_f32_16x16x32_bf16 v[212:215], v[24:27], v[132:135], v[212:215]
    v_mfma_f32_16x16x32_bf16 v[216:219], v[34:37], v[132:135], v[216:219]
    v_mfma_f32_16x16x32_bf16 v[220:223], v[44:47], v[132:135], v[220:223]
    v_mfma_f32_16x16x32_bf16 v[224:227], v[54:57], v[132:135], v[224:227]
    v_mfma_f32_16x16x32_bf16 v[228:231], v[64:67], v[132:135], v[228:231]
    s_nop 3
    v_mul_f32 v212, s47, v212
    v_mul_f32 v213, s47, v213
    v_mul_f32 v214, s47, v214
    v_mul_f32 v215, s47, v215
    v_mul_f32 v216, s47, v216
    v_mul_f32 v217, s47, v217
    v_mul_f32 v218, s47, v218
    v_mul_f32 v219, s47, v219
    v_mul_f32 v220, s47, v220
    v_mul_f32 v221, s47, v221
    v_mul_f32 v222, s47, v222
    v_mul_f32 v223, s47, v223
    v_mul_f32 v224, s47, v224
    v_mul_f32 v225, s47, v225
    v_mul_f32 v226, s47, v226
    v_mul_f32 v227, s47, v227
    v_mul_f32 v228, s47, v228
    v_mul_f32 v229, s47, v229
    v_mul_f32 v230, s47, v230
    v_mul_f32 v231, s47, v231
    s_barrier
    s_cmp_eq_u32 s3, 7
    s_cbranch_scc0 L_nopub2
    s_lshl_b32 s50, s39, 7
    s_add_u32 s50, s50, 29425664
    v_mov_b32 v24, s48
    v_mov_b32 v25, s49
    v_mov_b32 v26, 0
    s_mov_b64 exec, 1
    buffer_store_dwordx2 v[24:25], v26, s[28:31], s50 offen sc1
    s_mov_b64 exec, -1
    v_mov_b32 v26, 163832
    ds_write_b64 v26, v[24:25]
L_nopub2:
    s_mov_b32 s60, s0
    s_mov_b32 s61, s1
    s_mov_b32 s62, 2621440
    s_mov_b32 s63, 0x20000
    s_mov_b32 s56, s18
    s_mov_b32 s57, s19
    s_mov_b32 s58, 1280
    s_mov_b32 s59, 0x20000
    s_and_b32 s53, s39, 15
    s_lshl_b32 s53, s53, 4
    s_lshr_b32 s50, s39, 4
    s_add_u32 s53, s53, s50
    s_lshl_b32 s53, s53, 2
    s_add_u32 s53, s53, s36
    s_mul_i32 s50, s53, 2560
    v_lshlrev_b32 v9, 2, v1
    buffer_load_dword v72, v9, s[60:63], s50 offen offset:0
    buffer_load_dword v73, v9, s[60:63], s50 offen offset:256
    buffer_load_dword v74, v9, s[60:63], s50 offen offset:512
    buffer_load_dword v75, v9, s[60:63], s50 offen offset:768
    buffer_load_dword v76, v9, s[60:63], s50 offen offset:1024
    buffer_load_dword v77, v9, s[60:63], s50 offen offset:1280
    buffer_load_dword v78, v9, s[60:63], s50 offen offset:1536
    buffer_load_dword v79, v9, s[60:63], s50 offen offset:1792
    buffer_load_dword v80, v9, s[60:63], s50 offen offset:2048
    buffer_load_dword v81, v9, s[60:63], s50 offen offset:2304
    buffer_load_dword v82, v9, s[56:59], 0 offen offset:0
    buffer_load_dword v83, v9, s[56:59], 0 offen offset:256
    buffer_load_dword v84, v9, s[56:59], 0 offen offset:512
    buffer_load_dword v85, v9, s[56:59], 0 offen offset:768
    buffer_load_dword v86, v9, s[56:59], 0 offen offset:1024
    s_lshl_b32 s53, s53, 7
    s_add_u32 s53, s53, 29491200
    v_max3_f32 v11, abs(v212), abs(v213), abs(v214)
    v_max3_f32 v12, abs(v215), abs(v216), abs(v217)
    v_max3_f32 v12, abs(v218), abs(v219), v12
    v_max3_f32 v11, abs(v220), abs(v221), v11
    v_max3_f32 v12, abs(v222), abs(v223), v12
    v_max3_f32 v11, abs(v224), abs(v225), v11
    v_max3_f32 v12, abs(v226), abs(v227), v12
    v_max3_f32 v11, abs(v228), abs(v229), v11
    v_max3_f32 v12, abs(v230), abs(v231), v12
    v_max_f32 v11, v11, v12
    v_exp_f32 v132, v212
    v_exp_f32 v133, v213
    v_exp_f32 v134, v214
    v_exp_f32 v135, v215
    v_exp_f32 v136, v216
    v_exp_f32 v137, v217
    v_exp_f32 v138, v218
    v_exp_f32 v139, v219
    v_exp_f32 v140, v220
    v_exp_f32 v141, v221
    v_exp_f32 v142, v222
    v_exp_f32 v143, v223
    v_exp_f32 v144, v224
    v_exp_f32 v145, v225
    v_exp_f32 v146, v226
    v_exp_f32 v147, v227
    v_exp_f32 v148, v228
    v_exp_f32 v149, v229
    v_exp_f32 v150, v230
    v_exp_f32 v151, v231
    v_exp_f32 v112, -v212
    v_exp_f32 v113, -v213
    v_exp_f32 v114, -v214
    v_exp_f32 v115, -v215
    v_exp_f32 v116, -v216
    v_exp_f32 v117, -v217
    v_exp_f32 v118, -v218
    v_exp_f32 v119, -v219
    v_exp_f32 v120, -v220
    v_exp_f32 v121, -v221
    v_exp_f32 v122, -v222
    v_exp_f32 v123, -v223
    v_exp_f32 v124, -v224
    v_exp_f32 v125, -v225
    v_exp_f32 v126, -v226
    v_exp_f32 v127, -v227
    v_exp_f32 v128, -v228
    v_cmp_lt_f32 vcc, 1119879168, v11
    v_exp_f32 v129, -v229
    v_exp_f32 v130, -v230
    v_exp_f32 v131, -v231
    s_cbranch_vccnz L_psa1
L_pra1:
    s_barrier
    v_pk_add_f32 v[16:17], v[132:133], v[134:135]
    v_pk_add_f32 v[18:19], v[112:113], v[114:115]
    v_pk_add_f32 v[16:17], v[16:17], v[136:137]
    v_pk_add_f32 v[18:19], v[18:19], v[116:117]
    v_pk_add_f32 v[16:17], v[16:17], v[138:139]
    v_pk_add_f32 v[18:19], v[18:19], v[118:119]
    v_pk_add_f32 v[16:17], v[16:17], v[140:141]
    v_pk_add_f32 v[18:19], v[18:19], v[120:121]
    v_pk_add_f32 v[16:17], v[16:17], v[142:143]
    v_pk_add_f32 v[18:19], v[18:19], v[122:123]
    v_pk_add_f32 v[16:17], v[16:17], v[144:145]
    v_pk_add_f32 v[18:19], v[18:19], v[124:125]
    v_pk_add_f32 v[16:17], v[16:17], v[146:147]
    v_pk_add_f32 v[18:19], v[18:19], v[126:127]
    v_pk_add_f32 v[16:17], v[16:17], v[148:149]
    v_pk_add_f32 v[18:19], v[18:19], v[128:129]
    v_pk_add_f32 v[16:17], v[16:17], v[150:151]
    v_pk_add_f32 v[18:19], v[18:19], v[130:131]
    v_add_f32 v16, v16, v17
    v_add_f32 v18, v18, v19
    v_rcp_f32 v16, v16
    v_rcp_f32 v18, v18
    s_cmp_eq_u32 s3, 7
    s_cselect_b64 exec, -1, 0
    s_mov_b32 s50, 29425664
    buffer_load_dwordx2 v[22:23], v70, s[28:31], s50 offen sc1
    s_mov_b64 exec, -1
    v_pk_mul_f32 v[132:133], v[132:133], v[16:17] op_sel_hi:[1,0]
    v_pk_mul_f32 v[134:135], v[134:135], v[16:17] op_sel_hi:[1,0]
    v_pk_mul_f32 v[136:137], v[136:137], v[16:17] op_sel_hi:[1,0]
    v_pk_mul_f32 v[138:139], v[138:139], v[16:17] op_sel_hi:[1,0]
    v_cvt_pk_bf16_f32 v132, v132, v133
    v_cvt_pk_bf16_f32 v133, v134, v135
    v_cvt_pk_bf16_f32 v134, v136, v137
    v_cvt_pk_bf16_f32 v135, v138, v139
    ds_write_b128 v234, v[132:135] offset:0
    v_pk_mul_f32 v[140:141], v[140:141], v[16:17] op_sel_hi:[1,0]
    v_pk_mul_f32 v[142:143], v[142:143], v[16:17] op_sel_hi:[1,0]
    v_pk_mul_f32 v[144:145], v[144:145], v[16:17] op_sel_hi:[1,0]
    v_pk_mul_f32 v[146:147], v[146:147], v[16:17] op_sel_hi:[1,0]
    v_cvt_pk_bf16_f32 v140, v140, v141
    v_cvt_pk_bf16_f32 v141, v142, v143
    v_cvt_pk_bf16_f32 v142, v144, v145
    v_cvt_pk_bf16_f32 v143, v146, v147
    ds_write_b128 v234, v[140:143] offset:16
    v_pk_mul_f32 v[148:149], v[148:149], v[16:17] op_sel_hi:[1,0]
    v_pk_mul_f32 v[150:151], v[150:151], v[16:17] op_sel_hi:[1,0]
    v_pk_mul_f32 v[112:113], v[112:113], v[18:19] op_sel_hi:[1,0]
    v_pk_mul_f32 v[114:115], v[114:115], v[18:19] op_sel_hi:[1,0]
    v_cvt_pk_bf16_f32 v148, v148, v149
    v_cvt_pk_bf16_f32 v149, v150, v151
    v_cvt_pk_bf16_f32 v150, v112, v113
    v_cvt_pk_bf16_f32 v151, v114, v115
    ds_write_b128 v234, v[148:151] offset:32
    v_pk_mul_f32 v[116:117], v[116:117], v[18:19] op_sel_hi:[1,0]
    v_pk_mul_f32 v[118:119], v[118:119], v[18:19] op_sel_hi:[1,0]
    v_pk_mul_f32 v[120:121], v[120:121], v[18:19] op_sel_hi:[1,0]
    v_pk_mul_f32 v[122:123], v[122:123], v[18:19] op_sel_hi:[1,0]
    v_cvt_pk_bf16_f32 v116, v116, v117
    v_cvt_pk_bf16_f32 v117, v118, v119
    v_cvt_pk_bf16_f32 v118, v120, v121
    v_cvt_pk_bf16_f32 v119, v122, v123
    ds_write_b128 v234, v[116:119] offset:48
    v_pk_mul_f32 v[124:125], v[124:125], v[18:19] op_sel_hi:[1,0]
    v_pk_mul_f32 v[126:127], v[126:127], v[18:19] op_sel_hi:[1,0]
    v_pk_mul_f32 v[128:129], v[128:129], v[18:19] op_sel_hi:[1,0]
    v_pk_mul_f32 v[130:131], v[130:131], v[18:19] op_sel_hi:[1,0]
    v_cvt_pk_bf16_f32 v124, v124, v125
    v_cvt_pk_bf16_f32 v125, v126, v127
    v_cvt_pk_bf16_f32 v126, v128, v129
    v_cvt_pk_bf16_f32 v127, v130, v131
    ds_write_b128 v234, v[124:127] offset:64
    s_mov_b64 exec, 1
    ds_add_u32 v8, v10 offset:4
    s_mov_b64 exec, -1
    s_setprio 3
    s_branch L_ldone
L_pre1:
    s_lshr_b32 s60, s58, 1
    s_mul_i32 s60, s60, 5632
    s_and_b32 s50, s59, 1
    s_mul_i32 s50, s50, 1536
    s_add_u32 s60, s60, s50
    s_mul_i32 s50, s41, 720896
    s_add_u32 s60, s60, s50
    s_add_u32 s60, s60, 6294016
    v_lshrrev_b32 v11, 2, v3
    s_mov_b32 s50, 180224
    v_mul_lo_u32 v12, v11, s50
    v_mul_u32_u24 v13, 384, v4
    v_add_u32 v12, v12, v13
    v_and_b32 v13, 3, v1
    v_lshl_add_u32 v232, v13, 4, v12
    v_mov_b32 v108, 0x3f803f80
    v_mov_b32 v109, 0x3f803f80
    v_mov_b32 v110, 0x3f803f80
    v_mov_b32 v111, 0x3f803f80
    v_mul_u32_u24 v11, 1728, v11
    v_mul_u32_u24 v12, 80, v13
    v_add_u32 v11, v11, v12
    v_lshl_add_u32 v11, v4, 4, v11
    s_lshr_b32 s50, s36, 1
    s_mul_i32 s50, s50, 47104
    s_and_b32 s51, s36, 1
    s_mul_i32 s51, s51, 6912
    s_add_u32 s50, s50, s51
    s_add_u32 s50, s50, 73344
    v_add_u32 v233, s50, v11
    v_mul_u32_u24 v11, 352, v3
    v_and_b32 v16, 4, v3
    v_lshl_add_u32 v11, v16, 2, v11
    v_and_b32 v16, 8, v3
    v_lshl_add_u32 v11, v16, 4, v11
    v_mul_u32_u24 v12, 80, v4
    v_add_u32 v11, v11, v12
    s_lshr_b32 s50, s36, 1
    s_mul_i32 s50, s50, 47104
    s_and_b32 s51, s36, 1
    s_mul_i32 s51, s51, 5760
    s_add_u32 s50, s50, s51
    s_add_u32 s50, s50, 52864
    v_add_u32 v234, s50, v11
    s_lshr_b32 s50, s36, 1
    s_mul_i32 s50, s50, 47104
    s_and_b32 s51, s36, 1
    s_mul_i32 s51, s51, 20480
    s_add_u32 s50, s50, s51
    s_add_u32 s61, s50, 52864
    v_bfrev_b32 v17, v4
    v_lshrrev_b32 v17, 30, v17
    v_bfe_u32 v12, v1, 2, 2
    v_lshl_add_u32 v12, v17, 2, v12
    v_mul_u32_u24 v11, 352, v12
    v_and_b32 v16, 4, v12
    v_lshl_add_u32 v11, v16, 2, v11
    v_and_b32 v16, 8, v12
    v_lshl_add_u32 v11, v16, 4, v11
    v_lshl_add_u32 v11, v13, 3, v11
    s_mul_i32 s50, s3, 80
    s_add_u32 s50, s50, 47104
    v_add_u32 v235, s50, v11
    v_lshlrev_b32 v11, 6, v3
    v_lshl_add_u32 v241, v4, 4, v11
    s_mul_i32 s50, s3, 1728
    s_add_u32 s50, s50, 73344
    v_mul_u32_u24 v11, 80, v3
    v_lshl_add_u32 v11, v17, 4, v11
    v_add_u32 v236, s50, v11
    s_lshl_b32 s75, s41, 2
    s_add_u32 s75, s75, s3
    s_mul_i32 s75, s75, 98304
    s_mul_i32 s50, s40, 6144
    s_add_u32 s75, s75, s50
    s_add_u32 s75, s75, 17825792
    s_movk_i32 s76, 1024
    s_mov_b32 s79, 1073741824
    v_cmp_gt_u32 vcc, 5, v3
    v_mov_b32 v12, 0
    v_mov_b32 v13, 1073741824
    v_cndmask_b32 v255, v13, v12, vcc
    s_barrier
    ds_read_b128 v[92:95], v9 offset:0
    ds_read_b128 v[96:99], v9 offset:2048
    ds_read_b64_tr_b16 v[32:33], v8 offset:20480
    ds_read_b64_tr_b16 v[34:35], v8 offset:23040
    ds_read_b64_tr_b16 v[36:37], v8 offset:20488
    ds_read_b64_tr_b16 v[38:39], v8 offset:23048
    ds_read_b64_tr_b16 v[40:41], v8 offset:20496
    ds_read_b64_tr_b16 v[42:43], v8 offset:23056
    ds_read_b64_tr_b16 v[44:45], v8 offset:20504
    ds_read_b64_tr_b16 v[46:47], v8 offset:23064
    ds_read_b64_tr_b16 v[48:49], v8 offset:20512
    ds_read_b64_tr_b16 v[50:51], v8 offset:23072
    ds_read_b64_tr_b16 v[52:53], v8 offset:25600
    ds_read_b64_tr_b16 v[54:55], v8 offset:28160
    ds_read_b64_tr_b16 v[56:57], v8 offset:25608
    ds_read_b64_tr_b16 v[58:59], v8 offset:28168
    s_waitcnt lgkmcnt(10)
.p2align 6
L_main1:
    v_mfma_f32_16x16x32_bf16 v[112:115], v[92:95], v[32:35], v[112:115]
    ds_read_b128 v[100:103], v10 offset:0
    ds_read_b128 v[104:107], v10 offset:2048
    v_mfma_f32_16x16x32_bf16 v[116:119], v[96:99], v[32:35], v[116:119]
    ds_read_b64_tr_b16 v[60:61], v8 offset:25616
    ds_read_b64_tr_b16 v[62:63], v8 offset:28176
    v_mfma_f32_16x16x32_bf16 v[120:123], v[92:95], v[36:39], v[120:123]
    ds_read_b64_tr_b16 v[64:65], v8 offset:25624
    v_mfma_f32_16x16x32_bf16 v[124:127], v[96:99], v[36:39], v[124:127]
    ds_read_b64_tr_b16 v[66:67], v8 offset:28184
    s_waitcnt lgkmcnt(12)
    v_mfma_f32_16x16x32_bf16 v[128:131], v[92:95], v[40:43], v[128:131]
    ds_read_b64_tr_b16 v[68:69], v8 offset:25632
    v_mfma_f32_16x16x32_bf16 v[132:135], v[96:99], v[40:43], v[132:135]
    ds_read_b64_tr_b16 v[70:71], v8 offset:28192
    v_mfma_f32_16x16x32_bf16 v[136:139], v[92:95], v[44:47], v[136:139]
    ds_read_b64_tr_b16 v[72:73], v8 offset:0
    v_mfma_f32_16x16x32_bf16 v[140:143], v[96:99], v[44:47], v[140:143]
    ds_read_b64_tr_b16 v[74:75], v8 offset:2560
    s_waitcnt lgkmcnt(8)
    v_mfma_f32_16x16x32_bf16 v[144:147], v[92:95], v[48:51], v[144:147]
    ds_read_b64_tr_b16 v[76:77], v8 offset:8
    v_mfma_f32_16x16x32_bf16 v[148:151], v[96:99], v[48:51], v[148:151]
    ds_read_b64_tr_b16 v[78:79], v8 offset:2568
    v_mfma_f32_16x16x32_bf16 v[112:115], v[100:103], v[52:55], v[112:115]
    ds_read_b64_tr_b16 v[80:81], v8 offset:16
    v_mfma_f32_16x16x32_bf16 v[116:119], v[104:107], v[52:55], v[116:119]
    ds_read_b64_tr_b16 v[82:83], v8 offset:2576
    s_waitcnt lgkmcnt(10)
    v_mfma_f32_16x16x32_bf16 v[120:123], v[100:103], v[56:59], v[120:123]
    ds_read_b64_tr_b16 v[84:85], v8 offset:24
    v_mfma_f32_16x16x32_bf16 v[124:127], v[104:107], v[56:59], v[124:127]
    ds_read_b64_tr_b16 v[86:87], v8 offset:2584
    v_mfma_f32_16x16x32_bf16 v[128:131], v[100:103], v[60:63], v[128:131]
    ds_read_b64_tr_b16 v[88:89], v8 offset:32
    v_mfma_f32_16x16x32_bf16 v[132:135], v[104:107], v[60:63], v[132:135]
    ds_read_b64_tr_b16 v[90:91], v8 offset:2592
    s_waitcnt lgkmcnt(10)
    v_mfma_f32_16x16x32_bf16 v[136:139], v[100:103], v[64:67], v[136:139]
    ds_read_b64_tr_b16 v[32:33], v8 offset:5120
    v_mfma_f32_16x16x32_bf16 v[140:143], v[104:107], v[64:67], v[140:143]
    ds_read_b64_tr_b16 v[34:35], v8 offset:7680
    v_mfma_f32_16x16x32_bf16 v[144:147], v[100:103], v[68:71], v[144:147]
    ds_read_b64_tr_b16 v[36:37], v8 offset:5128
    v_mfma_f32_16x16x32_bf16 v[148:151], v[104:107], v[68:71], v[148:151]
    ds_read_b64_tr_b16 v[38:39], v8 offset:7688
    s_waitcnt lgkmcnt(10)
    v_mfma_f32_16x16x32_bf16 v[192:195], v[72:75], v[92:95], v[192:195]
    ds_read_b64_tr_b16 v[40:41], v8 offset:5136
    v_mfma_f32_16x16x32_bf16 v[196:199], v[72:75], v[96:99], v[196:199]
    ds_read_b64_tr_b16 v[42:43], v8 offset:7696
    v_mfma_f32_16x16x32_bf16 v[200:203], v[76:79], v[92:95], v[200:203]
    ds_read_b64_tr_b16 v[44:45], v8 offset:5144
    v_mfma_f32_16x16x32_bf16 v[204:207], v[76:79], v[96:99], v[204:207]
    ds_read_b64_tr_b16 v[46:47], v8 offset:7704
    s_waitcnt lgkmcnt(10)
    v_mfma_f32_16x16x32_bf16 v[208:211], v[80:83], v[92:95], v[208:211]
    ds_read_b64_tr_b16 v[48:49], v8 offset:5152
    v_mfma_f32_16x16x32_bf16 v[212:215], v[80:83], v[96:99], v[212:215]
    ds_read_b64_tr_b16 v[50:51], v8 offset:7712
    v_mfma_f32_16x16x32_bf16 v[216:219], v[84:87], v[92:95], v[216:219]
    ds_read_b64_tr_b16 v[52:53], v8 offset:10240
    v_mfma_f32_16x16x32_bf16 v[220:223], v[84:87], v[96:99], v[220:223]
    ds_read_b64_tr_b16 v[54:55], v8 offset:12800
    s_waitcnt lgkmcnt(10)
    v_mfma_f32_16x16x32_bf16 v[224:227], v[88:91], v[92:95], v[224:227]
    ds_read_b64_tr_b16 v[56:57], v8 offset:10248
    v_mfma_f32_16x16x32_bf16 v[228:231], v[88:91], v[96:99], v[228:231]
    ds_read_b64_tr_b16 v[58:59], v8 offset:12808
    v_mfma_f32_16x16x32_bf16 v[192:195], v[32:35], v[100:103], v[192:195]
    ds_read_b64_tr_b16 v[60:61], v8 offset:10256
    v_mfma_f32_16x16x32_bf16 v[196:199], v[32:35], v[104:107], v[196:199]
    ds_read_b64_tr_b16 v[62:63], v8 offset:12816
    s_waitcnt lgkmcnt(10)
    v_mfma_f32_16x16x32_bf16 v[200:203], v[36:39], v[100:103], v[200:203]
    ds_read_b64_tr_b16 v[64:65], v8 offset:10264
    v_mfma_f32_16x16x32_bf16 v[204:207], v[36:39], v[104:107], v[204:207]
    ds_read_b64_tr_b16 v[66:67], v8 offset:12824
    v_mfma_f32_16x16x32_bf16 v[208:211], v[40:43], v[100:103], v[208:211]
    ds_read_b64_tr_b16 v[68:69], v8 offset:10272
    v_mfma_f32_16x16x32_bf16 v[212:215], v[40:43], v[104:107], v[212:215]
    ds_read_b64_tr_b16 v[70:71], v8 offset:12832
    s_waitcnt lgkmcnt(10)
    v_mfma_f32_16x16x32_bf16 v[216:219], v[44:47], v[100:103], v[216:219]
    ds_read_b64_tr_b16 v[72:73], v8 offset:15360
    v_mfma_f32_16x16x32_bf16 v[220:223], v[44:47], v[104:107], v[220:223]
    ds_read_b64_tr_b16 v[74:75], v8 offset:17920
    v_mfma_f32_16x16x32_bf16 v[224:227], v[48:51], v[100:103], v[224:227]
    ds_read_b64_tr_b16 v[76:77], v8 offset:15368
    v_mfma_f32_16x16x32_bf16 v[228:231], v[48:51], v[104:107], v[228:231]
    ds_read_b64_tr_b16 v[78:79], v8 offset:17928
    s_waitcnt lgkmcnt(10)
    v_mfma_f32_16x16x32_bf16 v[152:155], v[92:95], v[52:55], v[152:155]
    ds_read_b64_tr_b16 v[80:81], v8 offset:15376
    v_mfma_f32_16x16x32_bf16 v[156:159], v[96:99], v[52:55], v[156:159]
    ds_read_b64_tr_b16 v[82:83], v8 offset:17936
    v_mfma_f32_16x16x32_bf16 v[160:163], v[92:95], v[56:59], v[160:163]
    ds_read_b64_tr_b16 v[84:85], v8 offset:15384
    v_mfma_f32_16x16x32_bf16 v[164:167], v[96:99], v[56:59], v[164:167]
    ds_read_b64_tr_b16 v[86:87], v8 offset:17944
    s_waitcnt lgkmcnt(10)
    v_mfma_f32_16x16x32_bf16 v[168:171], v[92:95], v[60:63], v[168:171]
    ds_read_b64_tr_b16 v[88:89], v8 offset:15392
    v_mfma_f32_16x16x32_bf16 v[172:175], v[96:99], v[60:63], v[172:175]
    ds_read_b64_tr_b16 v[90:91], v8 offset:17952
    v_mfma_f32_16x16x32_bf16 v[176:179], v[92:95], v[64:67], v[176:179]
    s_add_u32 s57, s57, 1
    s_cmp_eq_u32 s57, 3
    v_mfma_f32_16x16x32_bf16 v[180:183], v[96:99], v[64:67], v[180:183]
    s_cselect_b32 s58, s56, s55
    s_cselect_b32 s57, 0, s57
    s_waitcnt lgkmcnt(8)
    v_mfma_f32_16x16x32_bf16 v[184:187], v[92:95], v[68:71], v[184:187]
    v_add_u32 v8, s58, v8
    v_add_u32 v9, s58, v9
    v_mfma_f32_16x16x32_bf16 v[188:191], v[96:99], v[68:71], v[188:191]
    v_add_u32 v10, s58, v10
    v_mfma_f32_16x16x32_bf16 v[152:155], v[100:103], v[72:75], v[152:155]
    s_waitcnt lgkmcnt(0)
    s_barrier
    v_mfma_f32_16x16x32_bf16 v[156:159], v[104:107], v[72:75], v[156:159]
    ds_read_b128 v[92:95], v9 offset:0
    ds_read_b128 v[96:99], v9 offset:2048
    v_mfma_f32_16x16x32_bf16 v[160:163], v[100:103], v[76:79], v[160:163]
    ds_read_b64_tr_b16 v[32:33], v8 offset:20480
    ds_read_b64_tr_b16 v[34:35], v8 offset:23040
    v_mfma_f32_16x16x32_bf16 v[164:167], v[104:107], v[76:79], v[164:167]
    ds_read_b64_tr_b16 v[36:37], v8 offset:20488
    ds_read_b64_tr_b16 v[38:39], v8 offset:23048
    v_mfma_f32_16x16x32_bf16 v[168:171], v[100:103], v[80:83], v[168:171]
    ds_read_b64_tr_b16 v[40:41], v8 offset:20496
    ds_read_b64_tr_b16 v[42:43], v8 offset:23056
    v_mfma_f32_16x16x32_bf16 v[172:175], v[104:107], v[80:83], v[172:175]
    ds_read_b64_tr_b16 v[44:45], v8 offset:20504
    ds_read_b64_tr_b16 v[46:47], v8 offset:23064
    v_mfma_f32_16x16x32_bf16 v[176:179], v[100:103], v[84:87], v[176:179]
    ds_read_b64_tr_b16 v[48:49], v8 offset:20512
    ds_read_b64_tr_b16 v[50:51], v8 offset:23072
    v_mfma_f32_16x16x32_bf16 v[180:183], v[104:107], v[84:87], v[180:183]
    ds_read_b64_tr_b16 v[52:53], v8 offset:25600
    ds_read_b64_tr_b16 v[54:55], v8 offset:28160
    v_mfma_f32_16x16x32_bf16 v[184:187], v[100:103], v[88:91], v[184:187]
    ds_read_b64_tr_b16 v[56:57], v8 offset:25608
    v_mfma_f32_16x16x32_bf16 v[188:191], v[104:107], v[88:91], v[188:191]
    ds_read_b64_tr_b16 v[58:59], v8 offset:28168
    s_add_u32 s54, s54, 1
    s_cmp_lt_u32 s54, 7
    s_waitcnt lgkmcnt(10)
    s_cbranch_scc1 L_main1
    buffer_store_dwordx4 v[108:111], v232, s[28:31], s60 offen offset:128 sc1
    s_lshl_b32 s50, s39, 7
    s_add_u32 s50, s50, 29425664
    v_mov_b32 v16, 0
    v_mov_b32 v17, 0
    s_cmp_eq_u32 s3, 1
    s_cselect_b64 exec, 0xffff, 0
    buffer_store_dwordx2 v[16:17], v253, s[28:31], s50 offen sc1
    buffer_store_dwordx2 v[16:17], v253, s[28:31], s72 offen sc1
    s_mov_b64 exec, -1
    v_mfma_f32_16x16x32_bf16 v[112:115], v[92:95], v[32:35], v[112:115]
    ds_read_b128 v[100:103], v10 offset:0
    ds_read_b128 v[104:107], v10 offset:2048
    v_mfma_f32_16x16x32_bf16 v[116:119], v[96:99], v[32:35], v[116:119]
    ds_read_b64_tr_b16 v[60:61], v8 offset:25616
    ds_read_b64_tr_b16 v[62:63], v8 offset:28176
    v_mfma_f32_16x16x32_bf16 v[120:123], v[92:95], v[36:39], v[120:123]
    ds_read_b64_tr_b16 v[64:65], v8 offset:25624
    v_mfma_f32_16x16x32_bf16 v[124:127], v[96:99], v[36:39], v[124:127]
    ds_read_b64_tr_b16 v[66:67], v8 offset:28184
    s_waitcnt lgkmcnt(12)
    v_mfma_f32_16x16x32_bf16 v[128:131], v[92:95], v[40:43], v[128:131]
    ds_read_b64_tr_b16 v[68:69], v8 offset:25632
    v_mfma_f32_16x16x32_bf16 v[132:135], v[96:99], v[40:43], v[132:135]
    ds_read_b64_tr_b16 v[70:71], v8 offset:28192
    v_mfma_f32_16x16x32_bf16 v[136:139], v[92:95], v[44:47], v[136:139]
    ds_read_b64_tr_b16 v[72:73], v8 offset:0
    v_mfma_f32_16x16x32_bf16 v[140:143], v[96:99], v[44:47], v[140:143]
    ds_read_b64_tr_b16 v[74:75], v8 offset:2560
    s_waitcnt lgkmcnt(8)
    v_mfma_f32_16x16x32_bf16 v[144:147], v[92:95], v[48:51], v[144:147]
    ds_read_b64_tr_b16 v[76:77], v8 offset:8
    v_mfma_f32_16x16x32_bf16 v[148:151], v[96:99], v[48:51], v[148:151]
    ds_read_b64_tr_b16 v[78:79], v8 offset:2568
    v_mfma_f32_16x16x32_bf16 v[112:115], v[100:103], v[52:55], v[112:115]
    ds_read_b64_tr_b16 v[80:81], v8 offset:16
    v_mfma_f32_16x16x32_bf16 v[116:119], v[104:107], v[52:55], v[116:119]
    ds_read_b64_tr_b16 v[82:83], v8 offset:2576
    s_waitcnt lgkmcnt(10)
    v_mfma_f32_16x16x32_bf16 v[120:123], v[100:103], v[56:59], v[120:123]
    ds_read_b64_tr_b16 v[84:85], v8 offset:24
    v_mfma_f32_16x16x32_bf16 v[124:127], v[104:107], v[56:59], v[124:127]
    ds_read_b64_tr_b16 v[86:87], v8 offset:2584
    v_mfma_f32_16x16x32_bf16 v[128:131], v[100:103], v[60:63], v[128:131]
    ds_read_b64_tr_b16 v[88:89], v8 offset:32
    v_mfma_f32_16x16x32_bf16 v[132:135], v[104:107], v[60:63], v[132:135]
    ds_read_b64_tr_b16 v[90:91], v8 offset:2592
    s_waitcnt lgkmcnt(10)
    v_mfma_f32_16x16x32_bf16 v[136:139], v[100:103], v[64:67], v[136:139]
    ds_read_b64_tr_b16 v[32:33], v8 offset:5120
    v_mfma_f32_16x16x32_bf16 v[140:143], v[104:107], v[64:67], v[140:143]
    ds_read_b64_tr_b16 v[34:35], v8 offset:7680
    v_mfma_f32_16x16x32_bf16 v[144:147], v[100:103], v[68:71], v[144:147]
    ds_read_b64_tr_b16 v[36:37], v8 offset:5128
    v_mfma_f32_16x16x32_bf16 v[148:151], v[104:107], v[68:71], v[148:151]
    ds_read_b64_tr_b16 v[38:39], v8 offset:7688
    s_waitcnt lgkmcnt(10)
    v_mfma_f32_16x16x32_bf16 v[192:195], v[72:75], v[92:95], v[192:195]
    ds_read_b64_tr_b16 v[40:41], v8 offset:5136
    v_mfma_f32_16x16x32_bf16 v[196:199], v[72:75], v[96:99], v[196:199]
    ds_read_b64_tr_b16 v[42:43], v8 offset:7696
    v_mfma_f32_16x16x32_bf16 v[200:203], v[76:79], v[92:95], v[200:203]
    ds_read_b64_tr_b16 v[44:45], v8 offset:5144
    v_mfma_f32_16x16x32_bf16 v[204:207], v[76:79], v[96:99], v[204:207]
    ds_read_b64_tr_b16 v[46:47], v8 offset:7704
    s_waitcnt lgkmcnt(10)
    v_mfma_f32_16x16x32_bf16 v[208:211], v[80:83], v[92:95], v[208:211]
    ds_read_b64_tr_b16 v[48:49], v8 offset:5152
    v_mfma_f32_16x16x32_bf16 v[212:215], v[80:83], v[96:99], v[212:215]
    ds_read_b64_tr_b16 v[50:51], v8 offset:7712
    v_mfma_f32_16x16x32_bf16 v[216:219], v[84:87], v[92:95], v[216:219]
    v_mfma_f32_16x16x32_bf16 v[220:223], v[84:87], v[96:99], v[220:223]
    s_waitcnt lgkmcnt(8)
    v_mfma_f32_16x16x32_bf16 v[224:227], v[88:91], v[92:95], v[224:227]
    v_add_u32 v8, 47104, v8
    v_add_u32 v9, 47104, v9
    v_mfma_f32_16x16x32_bf16 v[228:231], v[88:91], v[96:99], v[228:231]
    v_add_u32 v10, 47104, v10
    v_mfma_f32_16x16x32_bf16 v[192:195], v[32:35], v[100:103], v[192:195]
    s_waitcnt lgkmcnt(0)
    s_barrier
    v_mfma_f32_16x16x32_bf16 v[196:199], v[32:35], v[104:107], v[196:199]
    ds_read_b128 v[92:95], v9 offset:0
    ds_read_b128 v[96:99], v9 offset:2048
    v_mfma_f32_16x16x32_bf16 v[200:203], v[36:39], v[100:103], v[200:203]
    ds_read_b64_tr_b16 v[52:53], v8 offset:20480
    ds_read_b64_tr_b16 v[54:55], v8 offset:23040
    v_mfma_f32_16x16x32_bf16 v[204:207], v[36:39], v[104:107], v[204:207]
    ds_read_b64_tr_b16 v[56:57], v8 offset:20488
    ds_read_b64_tr_b16 v[58:59], v8 offset:23048
    v_mfma_f32_16x16x32_bf16 v[208:211], v[40:43], v[100:103], v[208:211]
    ds_read_b64_tr_b16 v[60:61], v8 offset:20496
    ds_read_b64_tr_b16 v[62:63], v8 offset:23056
    v_mfma_f32_16x16x32_bf16 v[212:215], v[40:43], v[104:107], v[212:215]
    ds_read_b64_tr_b16 v[64:65], v8 offset:20504
    ds_read_b64_tr_b16 v[66:67], v8 offset:23064
    v_mfma_f32_16x16x32_bf16 v[216:219], v[44:47], v[100:103], v[216:219]
    ds_read_b64_tr_b16 v[68:69], v8 offset:20512
    ds_read_b64_tr_b16 v[70:71], v8 offset:23072
    v_mfma_f32_16x16x32_bf16 v[220:223], v[44:47], v[104:107], v[220:223]
    ds_read_b64_tr_b16 v[72:73], v8 offset:25600
    ds_read_b64_tr_b16 v[74:75], v8 offset:28160
    v_mfma_f32_16x16x32_bf16 v[224:227], v[48:51], v[100:103], v[224:227]
    ds_read_b64_tr_b16 v[76:77], v8 offset:25608
    v_mfma_f32_16x16x32_bf16 v[228:231], v[48:51], v[104:107], v[228:231]
    ds_read_b64_tr_b16 v[78:79], v8 offset:28168
    s_waitcnt lgkmcnt(10)
    v_mfma_f32_16x16x32_bf16 v[112:115], v[92:95], v[52:55], v[112:115]
    ds_read_b128 v[100:103], v10 offset:0
    ds_read_b128 v[104:107], v10 offset:2048
    v_mfma_f32_16x16x32_bf16 v[116:119], v[96:99], v[52:55], v[116:119]
    ds_read_b64_tr_b16 v[80:81], v8 offset:25616
    ds_read_b64_tr_b16 v[82:83], v8 offset:28176
    v_mfma_f32_16x16x32_bf16 v[120:123], v[92:95], v[56:59], v[120:123]
    ds_read_b64_tr_b16 v[84:85], v8 offset:25624
    v_mfma_f32_16x16x32_bf16 v[124:127], v[96:99], v[56:59], v[124:127]
    ds_read_b64_tr_b16 v[86:87], v8 offset:28184
    s_waitcnt lgkmcnt(12)
    v_mfma_f32_16x16x32_bf16 v[128:131], v[92:95], v[60:63], v[128:131]
    ds_read_b64_tr_b16 v[88:89], v8 offset:25632
    v_mfma_f32_16x16x32_bf16 v[132:135], v[96:99], v[60:63], v[132:135]
    ds_read_b64_tr_b16 v[90:91], v8 offset:28192
    v_mfma_f32_16x16x32_bf16 v[136:139], v[92:95], v[64:67], v[136:139]
    ds_read_b64_tr_b16 v[32:33], v8 offset:0
    v_mfma_f32_16x16x32_bf16 v[140:143], v[96:99], v[64:67], v[140:143]
    ds_read_b64_tr_b16 v[34:35], v8 offset:2560
    s_waitcnt lgkmcnt(8)
    v_mfma_f32_16x16x32_bf16 v[144:147], v[92:95], v[68:71], v[144:147]
    ds_read_b64_tr_b16 v[36:37], v8 offset:8
    v_mfma_f32_16x16x32_bf16 v[148:151], v[96:99], v[68:71], v[148:151]
    ds_read_b64_tr_b16 v[38:39], v8 offset:2568
    v_mfma_f32_16x16x32_bf16 v[112:115], v[100:103], v[72:75], v[112:115]
    ds_read_b64_tr_b16 v[40:41], v8 offset:16
    v_mfma_f32_16x16x32_bf16 v[116:119], v[104:107], v[72:75], v[116:119]
    ds_read_b64_tr_b16 v[42:43], v8 offset:2576
    s_waitcnt lgkmcnt(10)
    v_mfma_f32_16x16x32_bf16 v[120:123], v[100:103], v[76:79], v[120:123]
    ds_read_b64_tr_b16 v[44:45], v8 offset:24
    v_mfma_f32_16x16x32_bf16 v[124:127], v[104:107], v[76:79], v[124:127]
    ds_read_b64_tr_b16 v[46:47], v8 offset:2584
    v_mfma_f32_16x16x32_bf16 v[128:131], v[100:103], v[80:83], v[128:131]
    ds_read_b64_tr_b16 v[48:49], v8 offset:32
    v_mfma_f32_16x16x32_bf16 v[132:135], v[104:107], v[80:83], v[132:135]
    ds_read_b64_tr_b16 v[50:51], v8 offset:2592
    s_waitcnt lgkmcnt(10)
    v_mfma_f32_16x16x32_bf16 v[136:139], v[100:103], v[84:87], v[136:139]
    ds_read_b64_tr_b16 v[52:53], v8 offset:5120
    v_mfma_f32_16x16x32_bf16 v[140:143], v[104:107], v[84:87], v[140:143]
    ds_read_b64_tr_b16 v[54:55], v8 offset:7680
    v_mfma_f32_16x16x32_bf16 v[144:147], v[100:103], v[88:91], v[144:147]
    ds_read_b64_tr_b16 v[56:57], v8 offset:5128
    v_mfma_f32_16x16x32_bf16 v[148:151], v[104:107], v[88:91], v[148:151]
    ds_read_b64_tr_b16 v[58:59], v8 offset:7688
    s_waitcnt lgkmcnt(10)
    v_mfma_f32_16x16x32_bf16 v[192:195], v[32:35], v[92:95], v[192:195]
    ds_read_b64_tr_b16 v[60:61], v8 offset:5136
    v_mfma_f32_16x16x32_bf16 v[196:199], v[32:35], v[96:99], v[196:199]
    ds_read_b64_tr_b16 v[62:63], v8 offset:7696
    v_mfma_f32_16x16x32_bf16 v[200:203], v[36:39], v[92:95], v[200:203]
    ds_read_b64_tr_b16 v[64:65], v8 offset:5144
    v_mfma_f32_16x16x32_bf16 v[204:207], v[36:39], v[96:99], v[204:207]
    ds_read_b64_tr_b16 v[66:67], v8 offset:7704
    s_waitcnt lgkmcnt(10)
    v_mfma_f32_16x16x32_bf16 v[208:211], v[40:43], v[92:95], v[208:211]
    ds_read_b64_tr_b16 v[68:69], v8 offset:5152
    v_mfma_f32_16x16x32_bf16 v[212:215], v[40:43], v[96:99], v[212:215]
    ds_read_b64_tr_b16 v[70:71], v8 offset:7712
    v_mfma_f32_16x16x32_bf16 v[216:219], v[44:47], v[92:95], v[216:219]
    v_mfma_f32_16x16x32_bf16 v[220:223], v[44:47], v[96:99], v[220:223]
    s_waitcnt lgkmcnt(8)
    v_mfma_f32_16x16x32_bf16 v[224:227], v[48:51], v[92:95], v[224:227]
    v_add_u32 v8, 4294873088, v8
    v_add_u32 v9, 4294873088, v9
    v_mfma_f32_16x16x32_bf16 v[228:231], v[48:51], v[96:99], v[228:231]
    v_add_u32 v10, 4294873088, v10
    v_mfma_f32_16x16x32_bf16 v[192:195], v[52:55], v[100:103], v[192:195]
    s_waitcnt lgkmcnt(0)
    s_barrier
    v_mfma_f32_16x16x32_bf16 v[196:199], v[52:55], v[104:107], v[196:199]
    ds_read_b128 v[92:95], v9 offset:0
    ds_read_b128 v[96:99], v9 offset:2048
    v_mfma_f32_16x16x32_bf16 v[200:203], v[56:59], v[100:103], v[200:203]
    ds_read_b64_tr_b16 v[72:73], v8 offset:20480
    ds_read_b64_tr_b16 v[74:75], v8 offset:23040
    v_mfma_f32_16x16x32_bf16 v[204:207], v[56:59], v[104:107], v[204:207]
    ds_read_b64_tr_b16 v[76:77], v8 offset:20488
    ds_read_b64_tr_b16 v[78:79], v8 offset:23048
    v_mfma_f32_16x16x32_bf16 v[208:211], v[60:63], v[100:103], v[208:211]
    ds_read_b64_tr_b16 v[80:81], v8 offset:20496
    ds_read_b64_tr_b16 v[82:83], v8 offset:23056
    v_mfma_f32_16x16x32_bf16 v[212:215], v[60:63], v[104:107], v[212:215]
    ds_read_b64_tr_b16 v[84:85], v8 offset:20504
    ds_read_b64_tr_b16 v[86:87], v8 offset:23064
    v_mfma_f32_16x16x32_bf16 v[216:219], v[64:67], v[100:103], v[216:219]
    ds_read_b64_tr_b16 v[88:89], v8 offset:20512
    ds_read_b64_tr_b16 v[90:91], v8 offset:23072
    v_mfma_f32_16x16x32_bf16 v[220:223], v[64:67], v[104:107], v[220:223]
    ds_read_b64_tr_b16 v[32:33], v8 offset:25600
    ds_read_b64_tr_b16 v[34:35], v8 offset:28160
    v_mfma_f32_16x16x32_bf16 v[224:227], v[68:71], v[100:103], v[224:227]
    ds_read_b64_tr_b16 v[36:37], v8 offset:25608
    v_mfma_f32_16x16x32_bf16 v[228:231], v[68:71], v[104:107], v[228:231]
    ds_read_b64_tr_b16 v[38:39], v8 offset:28168
    s_waitcnt lgkmcnt(10)
    v_mfma_f32_16x16x32_bf16 v[112:115], v[92:95], v[72:75], v[112:115]
    ds_read_b128 v[100:103], v10 offset:0
    ds_read_b128 v[104:107], v10 offset:2048
    v_mfma_f32_16x16x32_bf16 v[116:119], v[96:99], v[72:75], v[116:119]
    ds_read_b64_tr_b16 v[40:41], v8 offset:25616
    ds_read_b64_tr_b16 v[42:43], v8 offset:28176
    v_mfma_f32_16x16x32_bf16 v[120:123], v[92:95], v[76:79], v[120:123]
    ds_read_b64_tr_b16 v[44:45], v8 offset:25624
    v_mfma_f32_16x16x32_bf16 v[124:127], v[96:99], v[76:79], v[124:127]
    ds_read_b64_tr_b16 v[46:47], v8 offset:28184
    s_waitcnt lgkmcnt(12)
    v_mfma_f32_16x16x32_bf16 v[128:131], v[92:95], v[80:83], v[128:131]
    ds_read_b64_tr_b16 v[48:49], v8 offset:25632
    v_mfma_f32_16x16x32_bf16 v[132:135], v[96:99], v[80:83], v[132:135]
    ds_read_b64_tr_b16 v[50:51], v8 offset:28192
    v_mfma_f32_16x16x32_bf16 v[136:139], v[92:95], v[84:87], v[136:139]
    ds_read_b64_tr_b16 v[52:53], v8 offset:0
    v_mfma_f32_16x16x32_bf16 v[140:143], v[96:99], v[84:87], v[140:143]
    ds_read_b64_tr_b16 v[54:55], v8 offset:2560
    s_waitcnt lgkmcnt(8)
    v_mfma_f32_16x16x32_bf16 v[144:147], v[92:95], v[88:91], v[144:147]
    ds_read_b64_tr_b16 v[56:57], v8 offset:8
    v_mfma_f32_16x16x32_bf16 v[148:151], v[96:99], v[88:91], v[148:151]
    ds_read_b64_tr_b16 v[58:59], v8 offset:2568
    v_mfma_f32_16x16x32_bf16 v[112:115], v[100:103], v[32:35], v[112:115]
    ds_read_b64_tr_b16 v[60:61], v8 offset:16
    v_mfma_f32_16x16x32_bf16 v[116:119], v[104:107], v[32:35], v[116:119]
    ds_read_b64_tr_b16 v[62:63], v8 offset:2576
    s_waitcnt lgkmcnt(10)
    v_mfma_f32_16x16x32_bf16 v[120:123], v[100:103], v[36:39], v[120:123]
    ds_read_b64_tr_b16 v[64:65], v8 offset:24
    v_mfma_f32_16x16x32_bf16 v[124:127], v[104:107], v[36:39], v[124:127]
    ds_read_b64_tr_b16 v[66:67], v8 offset:2584
    v_mfma_f32_16x16x32_bf16 v[128:131], v[100:103], v[40:43], v[128:131]
    ds_read_b64_tr_b16 v[68:69], v8 offset:32
    v_cvt_pk_bf16_f32 v112, v112, v113
    v_cvt_pk_bf16_f32 v113, v114, v115
    v_mfma_f32_16x16x32_bf16 v[132:135], v[104:107], v[40:43], v[132:135]
    ds_read_b64_tr_b16 v[70:71], v8 offset:2592
    v_cvt_pk_bf16_f32 v114, v116, v117
    v_cvt_pk_bf16_f32 v115, v118, v119
    s_waitcnt lgkmcnt(10)
    v_mfma_f32_16x16x32_bf16 v[136:139], v[100:103], v[44:47], v[136:139]
    ds_read_b64_tr_b16 v[72:73], v8 offset:5120
    buffer_store_dwordx4 v[112:115], v232, s[28:31], s60 offen offset:0 sc1
    v_cvt_pk_bf16_f32 v120, v120, v121
    v_mfma_f32_16x16x32_bf16 v[140:143], v[104:107], v[44:47], v[140:143]
    ds_read_b64_tr_b16 v[74:75], v8 offset:7680
    v_cvt_pk_bf16_f32 v121, v122, v123
    v_cvt_pk_bf16_f32 v122, v124, v125
    v_mfma_f32_16x16x32_bf16 v[144:147], v[100:103], v[48:51], v[144:147]
    ds_read_b64_tr_b16 v[76:77], v8 offset:5128
    v_cvt_pk_bf16_f32 v123, v126, v127
    buffer_store_dwordx4 v[120:123], v232, s[28:31], s60 offen offset:256 sc1
    v_mfma_f32_16x16x32_bf16 v[148:151], v[104:107], v[48:51], v[148:151]
    ds_read_b64_tr_b16 v[78:79], v8 offset:7688
    v_cvt_pk_bf16_f32 v128, v128, v129
    v_cvt_pk_bf16_f32 v129, v130, v131
    s_waitcnt lgkmcnt(10)
    v_mfma_f32_16x16x32_bf16 v[192:195], v[52:55], v[92:95], v[192:195]
    ds_read_b64_tr_b16 v[80:81], v8 offset:5136
    v_cvt_pk_bf16_f32 v130, v132, v133
    v_cvt_pk_bf16_f32 v131, v134, v135
    v_mfma_f32_16x16x32_bf16 v[196:199], v[52:55], v[96:99], v[196:199]
    ds_read_b64_tr_b16 v[82:83], v8 offset:7696
    buffer_store_dwordx4 v[128:131], v232, s[28:31], s60 offen offset:192 sc1
    v_cvt_pk_bf16_f32 v136, v136, v137
    v_mfma_f32_16x16x32_bf16 v[200:203], v[56:59], v[92:95], v[200:203]
    ds_read_b64_tr_b16 v[84:85], v8 offset:5144
    v_cvt_pk_bf16_f32 v137, v138, v139
    v_cvt_pk_bf16_f32 v138, v140, v141
    v_cvt_pk_bf16_f32 v139, v142, v143
    v_mfma_f32_16x16x32_bf16 v[204:207], v[56:59], v[96:99], v[204:207]
    ds_read_b64_tr_b16 v[86:87], v8 offset:7704
    buffer_store_dwordx4 v[136:139], v232, s[28:31], s60 offen offset:64 sc1
    v_cvt_pk_bf16_f32 v144, v144, v145
    v_cvt_pk_bf16_f32 v145, v146, v147
    s_waitcnt lgkmcnt(10)
    v_mfma_f32_16x16x32_bf16 v[208:211], v[60:63], v[92:95], v[208:211]
    ds_read_b64_tr_b16 v[88:89], v8 offset:5152
    v_cvt_pk_bf16_f32 v146, v148, v149
    v_cvt_pk_bf16_f32 v147, v150, v151
    buffer_store_dwordx4 v[144:147], v232, s[28:31], s60 offen offset:320 sc1
    v_mfma_f32_16x16x32_bf16 v[212:215], v[60:63], v[96:99], v[212:215]
    ds_read_b64_tr_b16 v[90:91], v8 offset:7712
    ds_read_b64_tr_b16 v[16:17], v237 offset:0
    ds_read_b64_tr_b16 v[18:19], v237 offset:160
    ds_read_b64_tr_b16 v[20:21], v237 offset:320
    v_mfma_f32_16x16x32_bf16 v[216:219], v[64:67], v[92:95], v[216:219]
    ds_read_b64_tr_b16 v[22:23], v237 offset:480
    ds_read_b64_tr_b16 v[24:25], v237 offset:640
    ds_read_b64_tr_b16 v[26:27], v237 offset:8
    v_mfma_f32_16x16x32_bf16 v[220:223], v[64:67], v[96:99], v[220:223]
    ds_read_b64_tr_b16 v[28:29], v237 offset:168
    ds_read_b64_tr_b16 v[30:31], v237 offset:328
    ds_read_b64_tr_b16 v[32:33], v237 offset:488
    s_waitcnt lgkmcnt(15)
    v_mfma_f32_16x16x32_bf16 v[224:227], v[68:71], v[92:95], v[224:227]
    ds_read_b64_tr_b16 v[34:35], v237 offset:648
    ds_read_b64_tr_b16 v[36:37], v237 offset:16
    ds_read_b64_tr_b16 v[38:39], v237 offset:176
    v_mfma_f32_16x16x32_bf16 v[228:231], v[68:71], v[96:99], v[228:231]
    ds_read_b64_tr_b16 v[40:41], v237 offset:336
    ds_read_b64_tr_b16 v[42:43], v237 offset:496
    ds_read_b64_tr_b16 v[44:45], v237 offset:656
    v_mfma_f32_16x16x32_bf16 v[192:195], v[72:75], v[100:103], v[192:195]
    ds_read_b64_tr_b16 v[46:47], v237 offset:24
    ds_read_b64_tr_b16 v[48:49], v237 offset:184
    ds_read_b64_tr_b16 v[50:51], v237 offset:344
    v_mfma_f32_16x16x32_bf16 v[196:199], v[72:75], v[104:107], v[196:199]
    ds_read_b64_tr_b16 v[52:53], v237 offset:504
    ds_read_b64_tr_b16 v[54:55], v237 offset:664
    ds_read_b64_tr_b16 v[56:57], v237 offset:32
    s_waitcnt lgkmcnt(15)
    v_mfma_f32_16x16x32_bf16 v[200:203], v[76:79], v[100:103], v[200:203]
    ds_read_b64_tr_b16 v[58:59], v237 offset:192
    ds_read_b64_tr_b16 v[60:61], v237 offset:352
    ds_read_b64_tr_b16 v[62:63], v237 offset:512
    v_mfma_f32_16x16x32_bf16 v[204:207], v[76:79], v[104:107], v[204:207]
    ds_read_b64_tr_b16 v[64:65], v237 offset:672
    v_mov_b64 v[122:123], 0
    v_add_u32 v12, s61, v2
    v_mfma_f32_16x16x32_bf16 v[208:211], v[80:83], v[100:103], v[208:211]
    v_mfma_f32_16x16x32_bf16 v[212:215], v[80:83], v[104:107], v[212:215]
    v_mfma_f32_16x16x32_bf16 v[216:219], v[84:87], v[100:103], v[216:219]
    v_cvt_pk_bf16_f32 v124, v196, v197
    v_cvt_pk_bf16_f32 v125, v198, v199
    v_cvt_pk_bf16_f32 v112, v192, v193
    v_mfma_f32_16x16x32_bf16 v[220:223], v[84:87], v[104:107], v[220:223]
    v_cvt_pk_bf16_f32 v113, v194, v195
    v_mfma_f32_16x16x32_bf16 v[224:227], v[88:91], v[100:103], v[224:227]
    v_cvt_pk_bf16_f32 v126, v204, v205
    v_cvt_pk_bf16_f32 v127, v206, v207
    v_cvt_pk_bf16_f32 v114, v200, v201
    v_mfma_f32_16x16x32_bf16 v[228:231], v[88:91], v[104:107], v[228:231]
    v_cvt_pk_bf16_f32 v115, v202, v203
    ds_write_b128 v12, v[124:127]
    v_cvt_pk_bf16_f32 v128, v212, v213
    v_cvt_pk_bf16_f32 v129, v214, v215
    v_cvt_pk_bf16_f32 v116, v208, v209
    v_cvt_pk_bf16_f32 v117, v210, v211
    v_cvt_pk_bf16_f32 v130, v220, v221
    v_cvt_pk_bf16_f32 v131, v222, v223
    v_cvt_pk_bf16_f32 v118, v216, v217
    v_cvt_pk_bf16_f32 v119, v218, v219
    ds_write_b128 v12, v[128:131] offset:1024
    v_cvt_pk_bf16_f32 v132, v228, v229
    v_cvt_pk_bf16_f32 v133, v230, v231
    ds_write_b64 v12, v[132:133] offset:2048
    v_cvt_pk_bf16_f32 v120, v224, v225
    v_cvt_pk_bf16_f32 v121, v226, v227
    s_waitcnt lgkmcnt(3)
    v_mfma_f32_16x16x32_bf16 v[192:195], v[16:19], v[112:115], 0
    v_mov_b64 v[66:67], 0
    v_mfma_f32_16x16x32_bf16 v[196:199], v[26:29], v[112:115], 0
    v_mfma_f32_16x16x32_bf16 v[200:203], v[36:39], v[112:115], 0
    v_mfma_f32_16x16x32_bf16 v[204:207], v[46:49], v[112:115], 0
    v_mfma_f32_16x16x32_bf16 v[208:211], v[56:59], v[112:115], 0
    v_mfma_f32_16x16x32_bf16 v[192:195], v[20:23], v[116:119], v[192:195]
    v_mfma_f32_16x16x32_bf16 v[196:199], v[30:33], v[116:119], v[196:199]
    s_waitcnt lgkmcnt(0)
    s_barrier
    v_mfma_f32_16x16x32_bf16 v[200:203], v[40:43], v[116:119], v[200:203]
    v_add_u32 v9, 47104, v9
    ds_read_b128 v[92:95], v9 offset:0
    ds_read_b128 v[96:99], v9 offset:2048
    v_mfma_f32_16x16x32_bf16 v[204:207], v[50:53], v[116:119], v[204:207]
    v_add_u32 v8, 47104, v8
    ds_read_b64_tr_b16 v[68:69], v8 offset:10240
    ds_read_b64_tr_b16 v[70:71], v8 offset:12800
    v_mfma_f32_16x16x32_bf16 v[208:211], v[60:63], v[116:119], v[208:211]
    ds_read_b64_tr_b16 v[72:73], v8 offset:10248
    ds_read_b64_tr_b16 v[74:75], v8 offset:12808
    v_mfma_f32_16x16x32_bf16 v[192:195], v[24:27], v[120:123], v[192:195]
    ds_read_b64_tr_b16 v[76:77], v8 offset:10256
    ds_read_b64_tr_b16 v[78:79], v8 offset:12816
    v_mfma_f32_16x16x32_bf16 v[196:199], v[34:37], v[120:123], v[196:199]
    ds_read_b64_tr_b16 v[80:81], v8 offset:10264
    ds_read_b64_tr_b16 v[82:83], v8 offset:12824
    v_mfma_f32_16x16x32_bf16 v[200:203], v[44:47], v[120:123], v[200:203]
    v_add_u32 v10, 47104, v10
    ds_read_b128 v[100:103], v10 offset:0
    ds_read_b128 v[104:107], v10 offset:2048
    v_mfma_f32_16x16x32_bf16 v[204:207], v[54:57], v[120:123], v[204:207]
    ds_read_b64_tr_b16 v[84:85], v8 offset:10272
    ds_read_b64_tr_b16 v[86:87], v8 offset:12832
    v_mfma_f32_16x16x32_bf16 v[208:211], v[64:67], v[120:123], v[208:211]
    ds_read_b64_tr_b16 v[88:89], v8 offset:15360
    ds_read_b64_tr_b16 v[90:91], v8 offset:17920
    s_waitcnt lgkmcnt(10)
    v_mfma_f32_16x16x32_bf16 v[152:155], v[92:95], v[68:71], v[152:155]
    ds_read_b64_tr_b16 v[32:33], v8 offset:15368
    v_mul_f32 v192, s52, v192
    v_mul_f32 v193, s52, v193
    v_mfma_f32_16x16x32_bf16 v[156:159], v[96:99], v[68:71], v[156:159]
    ds_read_b64_tr_b16 v[34:35], v8 offset:17928
    v_mul_f32 v194, s52, v194
    v_mul_f32 v195, s52, v195
    v_mfma_f32_16x16x32_bf16 v[160:163], v[92:95], v[72:75], v[160:163]
    ds_read_b64_tr_b16 v[36:37], v8 offset:15376
    v_mul_f32 v196, s52, v196
    v_mul_f32 v197, s52, v197
    v_mfma_f32_16x16x32_bf16 v[164:167], v[96:99], v[72:75], v[164:167]
    ds_read_b64_tr_b16 v[38:39], v8 offset:17936
    v_mul_f32 v198, s52, v198
    v_mul_f32 v199, s52, v199
    s_waitcnt lgkmcnt(10)
    s_waitcnt vmcnt(0)
    s_barrier
    v_mfma_f32_16x16x32_bf16 v[168:171], v[92:95], v[76:79], v[168:171]
    ds_read_b64_tr_b16 v[40:41], v8 offset:15384
    v_mul_f32 v200, s52, v200
    v_mul_f32 v201, s52, v201
    v_mfma_f32_16x16x32_bf16 v[172:175], v[96:99], v[76:79], v[172:175]
    ds_read_b64_tr_b16 v[42:43], v8 offset:17944
    v_mul_f32 v202, s52, v202
    v_mul_f32 v203, s52, v203
    v_mfma_f32_16x16x32_bf16 v[176:179], v[92:95], v[80:83], v[176:179]
    ds_read_b64_tr_b16 v[44:45], v8 offset:15392
    v_mul_f32 v204, s52, v204
    v_mul_f32 v205, s52, v205
    v_mfma_f32_16x16x32_bf16 v[180:183], v[96:99], v[80:83], v[180:183]
    ds_read_b64_tr_b16 v[46:47], v8 offset:17952
    v_mul_f32 v206, s52, v206
    v_mul_f32 v207, s52, v207
    s_waitcnt lgkmcnt(8)
    v_mfma_f32_16x16x32_bf16 v[184:187], v[92:95], v[84:87], v[184:187]
    v_add_u32 v8, 47104, v8
    ds_read_b64_tr_b16 v[48:49], v8 offset:10240
    v_mul_f32 v208, s52, v208
    v_mul_f32 v209, s52, v209
    v_mfma_f32_16x16x32_bf16 v[188:191], v[96:99], v[84:87], v[188:191]
    ds_read_b64_tr_b16 v[50:51], v8 offset:12800
    v_mul_f32 v210, s52, v210
    v_mul_f32 v211, s52, v211
    v_mfma_f32_16x16x32_bf16 v[152:155], v[100:103], v[88:91], v[152:155]
    ds_read_b64_tr_b16 v[52:53], v8 offset:10248
    ds_read_b64_tr_b16 v[54:55], v8 offset:12808
    v_add_u32 v9, 47104, v9
    v_max3_f32 v11, abs(v192), abs(v193), abs(v194)
    v_max3_f32 v12, abs(v195), abs(v196), abs(v197)
    v_mfma_f32_16x16x32_bf16 v[156:159], v[104:107], v[88:91], v[156:159]
    ds_read_b128 v[92:95], v9 offset:0
    ds_read_b128 v[96:99], v9 offset:2048
    v_max3_f32 v12, abs(v198), abs(v199), v12
    v_max3_f32 v11, abs(v200), abs(v201), v11
    s_waitcnt lgkmcnt(10)
    v_mfma_f32_16x16x32_bf16 v[160:163], v[100:103], v[32:35], v[160:163]
    ds_read_b64_tr_b16 v[56:57], v8 offset:10256
    v_max3_f32 v12, abs(v202), abs(v203), v12
    v_max3_f32 v11, abs(v204), abs(v205), v11
    v_mfma_f32_16x16x32_bf16 v[164:167], v[104:107], v[32:35], v[164:167]
    ds_read_b64_tr_b16 v[58:59], v8 offset:12816
    v_max3_f32 v12, abs(v206), abs(v207), v12
    v_max3_f32 v11, abs(v208), abs(v209), v11
    v_mfma_f32_16x16x32_bf16 v[168:171], v[100:103], v[36:39], v[168:171]
    ds_read_b64_tr_b16 v[60:61], v8 offset:10264
    v_max3_f32 v12, abs(v210), abs(v211), v12
    v_max_f32 v11, v11, v12
    v_mfma_f32_16x16x32_bf16 v[172:175], v[104:107], v[36:39], v[172:175]
    ds_read_b64_tr_b16 v[62:63], v8 offset:12824
    v_exp_f32 v132, v192
    s_waitcnt lgkmcnt(10)
    v_mfma_f32_16x16x32_bf16 v[176:179], v[100:103], v[40:43], v[176:179]
    ds_read_b64_tr_b16 v[64:65], v8 offset:10272
    v_exp_f32 v133, v193
    v_mfma_f32_16x16x32_bf16 v[180:183], v[104:107], v[40:43], v[180:183]
    ds_read_b64_tr_b16 v[66:67], v8 offset:12832
    v_exp_f32 v134, v194
    v_mfma_f32_16x16x32_bf16 v[184:187], v[100:103], v[44:47], v[184:187]
    ds_read_b64_tr_b16 v[68:69], v8 offset:15360
    v_exp_f32 v135, v195
    v_mfma_f32_16x16x32_bf16 v[188:191], v[104:107], v[44:47], v[188:191]
    ds_read_b64_tr_b16 v[70:71], v8 offset:17920
    v_exp_f32 v136, v196
    s_waitcnt lgkmcnt(8)
    v_mfma_f32_16x16x32_bf16 v[152:155], v[92:95], v[48:51], v[152:155]
    ds_read_b64_tr_b16 v[72:73], v8 offset:15368
    ds_read_b64_tr_b16 v[74:75], v8 offset:17928
    v_add_u32 v10, 47104, v10
    v_exp_f32 v137, v197
    v_mfma_f32_16x16x32_bf16 v[156:159], v[96:99], v[48:51], v[156:159]
    ds_read_b128 v[100:103], v10 offset:0
    ds_read_b128 v[104:107], v10 offset:2048
    v_exp_f32 v138, v198
    v_mfma_f32_16x16x32_bf16 v[160:163], v[92:95], v[52:55], v[160:163]
    ds_read_b64_tr_b16 v[76:77], v8 offset:15376
    v_exp_f32 v139, v199
    v_mfma_f32_16x16x32_bf16 v[164:167], v[96:99], v[52:55], v[164:167]
    ds_read_b64_tr_b16 v[78:79], v8 offset:17936
    v_exp_f32 v140, v200
    s_waitcnt lgkmcnt(10)
    v_mfma_f32_16x16x32_bf16 v[168:171], v[92:95], v[56:59], v[168:171]
    ds_read_b64_tr_b16 v[80:81], v8 offset:15384
    v_exp_f32 v141, v201
    v_mfma_f32_16x16x32_bf16 v[172:175], v[96:99], v[56:59], v[172:175]
    ds_read_b64_tr_b16 v[82:83], v8 offset:17944
    v_exp_f32 v142, v202
    v_mfma_f32_16x16x32_bf16 v[176:179], v[92:95], v[60:63], v[176:179]
    ds_read_b64_tr_b16 v[84:85], v8 offset:15392
    v_exp_f32 v143, v203
    v_mfma_f32_16x16x32_bf16 v[180:183], v[96:99], v[60:63], v[180:183]
    ds_read_b64_tr_b16 v[86:87], v8 offset:17952
    v_exp_f32 v144, v204
    s_waitcnt lgkmcnt(6)
    v_mfma_f32_16x16x32_bf16 v[184:187], v[92:95], v[64:67], v[184:187]
    v_add_u32 v8, 4294873088, v8
    ds_read_b64_tr_b16 v[88:89], v8 offset:10240
    v_exp_f32 v145, v205
    v_mfma_f32_16x16x32_bf16 v[188:191], v[96:99], v[64:67], v[188:191]
    ds_read_b64_tr_b16 v[90:91], v8 offset:12800
    v_exp_f32 v146, v206
    v_mfma_f32_16x16x32_bf16 v[152:155], v[100:103], v[68:71], v[152:155]
    ds_read_b64_tr_b16 v[32:33], v8 offset:10248
    ds_read_b64_tr_b16 v[34:35], v8 offset:12808
    v_add_u32 v9, 4294873088, v9
    v_exp_f32 v147, v207
    v_mfma_f32_16x16x32_bf16 v[156:159], v[104:107], v[68:71], v[156:159]
    ds_read_b128 v[92:95], v9 offset:0
    ds_read_b128 v[96:99], v9 offset:2048
    v_exp_f32 v148, v208
    s_waitcnt lgkmcnt(10)
    v_mfma_f32_16x16x32_bf16 v[160:163], v[100:103], v[72:75], v[160:163]
    ds_read_b64_tr_b16 v[36:37], v8 offset:10256
    v_exp_f32 v149, v209
    v_mfma_f32_16x16x32_bf16 v[164:167], v[104:107], v[72:75], v[164:167]
    ds_read_b64_tr_b16 v[38:39], v8 offset:12816
    v_exp_f32 v150, v210
    v_mfma_f32_16x16x32_bf16 v[168:171], v[100:103], v[76:79], v[168:171]
    ds_read_b64_tr_b16 v[40:41], v8 offset:10264
    v_exp_f32 v151, v211
    v_mfma_f32_16x16x32_bf16 v[172:175], v[104:107], v[76:79], v[172:175]
    ds_read_b64_tr_b16 v[42:43], v8 offset:12824
    v_exp_f32 v112, -v192
    s_waitcnt lgkmcnt(10)
    v_mfma_f32_16x16x32_bf16 v[176:179], v[100:103], v[80:83], v[176:179]
    ds_read_b64_tr_b16 v[44:45], v8 offset:10272
    v_exp_f32 v113, -v193
    v_mfma_f32_16x16x32_bf16 v[180:183], v[104:107], v[80:83], v[180:183]
    ds_read_b64_tr_b16 v[46:47], v8 offset:12832
    v_exp_f32 v114, -v194
    v_mfma_f32_16x16x32_bf16 v[184:187], v[100:103], v[84:87], v[184:187]
    ds_read_b64_tr_b16 v[48:49], v8 offset:15360
    v_exp_f32 v115, -v195
    v_mfma_f32_16x16x32_bf16 v[188:191], v[104:107], v[84:87], v[188:191]
    ds_read_b64_tr_b16 v[50:51], v8 offset:17920
    v_exp_f32 v116, -v196
    s_waitcnt lgkmcnt(8)
    v_mfma_f32_16x16x32_bf16 v[152:155], v[92:95], v[88:91], v[152:155]
    ds_read_b64_tr_b16 v[52:53], v8 offset:15368
    ds_read_b64_tr_b16 v[54:55], v8 offset:17928
    v_add_u32 v10, 4294873088, v10
    v_exp_f32 v117, -v197
    v_mfma_f32_16x16x32_bf16 v[156:159], v[96:99], v[88:91], v[156:159]
    ds_read_b128 v[100:103], v10 offset:0
    ds_read_b128 v[104:107], v10 offset:2048
    v_exp_f32 v118, -v198
    v_mfma_f32_16x16x32_bf16 v[160:163], v[92:95], v[32:35], v[160:163]
    ds_read_b64_tr_b16 v[56:57], v8 offset:15376
    v_exp_f32 v119, -v199
    v_mfma_f32_16x16x32_bf16 v[164:167], v[96:99], v[32:35], v[164:167]
    ds_read_b64_tr_b16 v[58:59], v8 offset:17936
    v_exp_f32 v120, -v200
    s_waitcnt lgkmcnt(10)
    v_mfma_f32_16x16x32_bf16 v[168:171], v[92:95], v[36:39], v[168:171]
    ds_read_b64_tr_b16 v[60:61], v8 offset:15384
    v_exp_f32 v121, -v201
    v_mfma_f32_16x16x32_bf16 v[172:175], v[96:99], v[36:39], v[172:175]
    ds_read_b64_tr_b16 v[62:63], v8 offset:17944
    v_exp_f32 v122, -v202
    v_mfma_f32_16x16x32_bf16 v[176:179], v[92:95], v[40:43], v[176:179]
    ds_read_b64_tr_b16 v[64:65], v8 offset:15392
    v_exp_f32 v123, -v203
    v_mfma_f32_16x16x32_bf16 v[180:183], v[96:99], v[40:43], v[180:183]
    ds_read_b64_tr_b16 v[66:67], v8 offset:17952
    v_exp_f32 v124, -v204
    s_waitcnt lgkmcnt(6)
    v_mfma_f32_16x16x32_bf16 v[184:187], v[92:95], v[44:47], v[184:187]
    v_exp_f32 v125, -v205
    v_mfma_f32_16x16x32_bf16 v[188:191], v[96:99], v[44:47], v[188:191]
    v_exp_f32 v126, -v206
    v_mfma_f32_16x16x32_bf16 v[152:155], v[100:103], v[48:51], v[152:155]
    v_exp_f32 v127, -v207
    v_mfma_f32_16x16x32_bf16 v[156:159], v[104:107], v[48:51], v[156:159]
    v_exp_f32 v128, -v208
    s_waitcnt lgkmcnt(4)
    s_waitcnt lgkmcnt(0)
    s_barrier
    v_mfma_f32_16x16x32_bf16 v[160:163], v[100:103], v[52:55], v[160:163]
    v_cmp_lt_f32 vcc, 1119879168, v11
    v_exp_f32 v129, -v209
    v_mfma_f32_16x16x32_bf16 v[164:167], v[104:107], v[52:55], v[164:167]
    v_exp_f32 v130, -v210
    v_mfma_f32_16x16x32_bf16 v[168:171], v[100:103], v[56:59], v[168:171]
    v_exp_f32 v131, -v211
    v_mfma_f32_16x16x32_bf16 v[172:175], v[104:107], v[56:59], v[172:175]
    v_mfma_f32_16x16x32_bf16 v[176:179], v[100:103], v[60:63], v[176:179]
    v_mfma_f32_16x16x32_bf16 v[180:183], v[104:107], v[60:63], v[180:183]
    v_mfma_f32_16x16x32_bf16 v[184:187], v[100:103], v[64:67], v[184:187]
    v_mfma_f32_16x16x32_bf16 v[188:191], v[104:107], v[64:67], v[188:191]
    s_cbranch_vccnz L_psa0
L_pra0:
    v_pk_add_f32 v[16:17], v[132:133], v[134:135]
    v_pk_add_f32 v[18:19], v[112:113], v[114:115]
    v_pk_add_f32 v[16:17], v[16:17], v[136:137]
    v_pk_add_f32 v[18:19], v[18:19], v[116:117]
    v_pk_add_f32 v[16:17], v[16:17], v[138:139]
    v_pk_add_f32 v[18:19], v[18:19], v[118:119]
    v_pk_add_f32 v[16:17], v[16:17], v[140:141]
    v_pk_add_f32 v[18:19], v[18:19], v[120:121]
    v_pk_add_f32 v[16:17], v[16:17], v[142:143]
    v_pk_add_f32 v[18:19], v[18:19], v[122:123]
    v_pk_add_f32 v[16:17], v[16:17], v[144:145]
    v_pk_add_f32 v[18:19], v[18:19], v[124:125]
    v_pk_add_f32 v[16:17], v[16:17], v[146:147]
    v_pk_add_f32 v[18:19], v[18:19], v[126:127]
    v_pk_add_f32 v[16:17], v[16:17], v[148:149]
    v_pk_add_f32 v[18:19], v[18:19], v[128:129]
    v_pk_add_f32 v[16:17], v[16:17], v[150:151]
    v_pk_add_f32 v[18:19], v[18:19], v[130:131]
    v_add_f32 v16, v16, v17
    v_add_f32 v18, v18, v19
    v_rcp_f32 v16, v16
    v_rcp_f32 v18, v18
    v_pk_mul_f32 v[132:133], v[132:133], v[16:17] op_sel_hi:[1,0]
    v_pk_mul_f32 v[134:135], v[134:135], v[16:17] op_sel_hi:[1,0]
    v_pk_mul_f32 v[136:137], v[136:137], v[16:17] op_sel_hi:[1,0]
    v_pk_mul_f32 v[138:139], v[138:139], v[16:17] op_sel_hi:[1,0]
    v_cvt_pk_bf16_f32 v132, v132, v133
    v_cvt_pk_bf16_f32 v133, v134, v135
    v_cvt_pk_bf16_f32 v134, v136, v137
    v_cvt_pk_bf16_f32 v135, v138, v139
    ds_write_b128 v234, v[132:135] offset:0
    v_pk_mul_f32 v[140:141], v[140:141], v[16:17] op_sel_hi:[1,0]
    v_pk_mul_f32 v[142:143], v[142:143], v[16:17] op_sel_hi:[1,0]
    v_pk_mul_f32 v[144:145], v[144:145], v[16:17] op_sel_hi:[1,0]
    v_pk_mul_f32 v[146:147], v[146:147], v[16:17] op_sel_hi:[1,0]
    v_cvt_pk_bf16_f32 v140, v140, v141
    v_cvt_pk_bf16_f32 v141, v142, v143
    v_cvt_pk_bf16_f32 v142, v144, v145
    v_cvt_pk_bf16_f32 v143, v146, v147
    ds_write_b128 v234, v[140:143] offset:16
    v_pk_mul_f32 v[148:149], v[148:149], v[16:17] op_sel_hi:[1,0]
    v_pk_mul_f32 v[150:151], v[150:151], v[16:17] op_sel_hi:[1,0]
    v_pk_mul_f32 v[112:113], v[112:113], v[18:19] op_sel_hi:[1,0]
    v_pk_mul_f32 v[114:115], v[114:115], v[18:19] op_sel_hi:[1,0]
    v_cvt_pk_bf16_f32 v148, v148, v149
    v_cvt_pk_bf16_f32 v149, v150, v151
    v_cvt_pk_bf16_f32 v150, v112, v113
    v_cvt_pk_bf16_f32 v151, v114, v115
    ds_write_b128 v234, v[148:151] offset:32
    v_pk_mul_f32 v[116:117], v[116:117], v[18:19] op_sel_hi:[1,0]
    v_pk_mul_f32 v[118:119], v[118:119], v[18:19] op_sel_hi:[1,0]
    v_pk_mul_f32 v[120:121], v[120:121], v[18:19] op_sel_hi:[1,0]
    v_pk_mul_f32 v[122:123], v[122:123], v[18:19] op_sel_hi:[1,0]
    v_cvt_pk_bf16_f32 v116, v116, v117
    v_cvt_pk_bf16_f32 v117, v118, v119
    v_cvt_pk_bf16_f32 v118, v120, v121
    v_cvt_pk_bf16_f32 v119, v122, v123
    ds_write_b128 v234, v[116:119] offset:48
    v_pk_mul_f32 v[124:125], v[124:125], v[18:19] op_sel_hi:[1,0]
    v_pk_mul_f32 v[126:127], v[126:127], v[18:19] op_sel_hi:[1,0]
    v_pk_mul_f32 v[128:129], v[128:129], v[18:19] op_sel_hi:[1,0]
    v_pk_mul_f32 v[130:131], v[130:131], v[18:19] op_sel_hi:[1,0]
    v_cvt_pk_bf16_f32 v124, v124, v125
    v_cvt_pk_bf16_f32 v125, v126, v127
    v_cvt_pk_bf16_f32 v126, v128, v129
    v_cvt_pk_bf16_f32 v127, v130, v131
    ds_write_b128 v234, v[124:127] offset:64
    v_mov_b32 v8, 163824
    v_mov_b32 v10, 1
    v_add_u32 v11, 47104, v235
    v_cvt_pk_bf16_f32 v152, v152, v153
    v_cvt_pk_bf16_f32 v153, v154, v155
    v_cvt_pk_bf16_f32 v154, v156, v157
    v_cvt_pk_bf16_f32 v155, v158, v159
    ds_write_b128 v233, v[152:155] offset:0
    v_cvt_pk_bf16_f32 v160, v160, v161
    v_cvt_pk_bf16_f32 v161, v162, v163
    v_cvt_pk_bf16_f32 v162, v164, v165
    v_cvt_pk_bf16_f32 v163, v166, v167
    ds_write_b128 v233, v[160:163] offset:320
    v_cvt_pk_bf16_f32 v168, v168, v169
    v_cvt_pk_bf16_f32 v169, v170, v171
    v_cvt_pk_bf16_f32 v170, v172, v173
    v_cvt_pk_bf16_f32 v171, v174, v175
    ds_write_b128 v233, v[168:171] offset:640
    v_cvt_pk_bf16_f32 v176, v176, v177
    v_cvt_pk_bf16_f32 v177, v178, v179
    v_cvt_pk_bf16_f32 v178, v180, v181
    v_cvt_pk_bf16_f32 v179, v182, v183
    ds_write_b128 v233, v[176:179] offset:960
    v_cvt_pk_bf16_f32 v184, v184, v185
    v_cvt_pk_bf16_f32 v185, v186, v187
    v_cvt_pk_bf16_f32 v186, v188, v189
    v_cvt_pk_bf16_f32 v187, v190, v191
    ds_write_b128 v233, v[184:187] offset:1280
    s_mov_b32 exec_lo, 0x11111111
    s_mov_b32 exec_hi, 0x11111111
    ds_write_b128 v233, v[108:111] offset:1600
    s_mov_b64 exec, 1
    ds_add_u32 v8, v10 offset:4
    s_mov_b64 exec, -1
L_kvw:
    ds_read_b32 v9, v8 offset:4
    s_waitcnt lgkmcnt(0)
    v_cmp_ne_u32 vcc, 8, v9
    s_cbranch_vccnz L_kvw
    ds_read_b128 v[156:159], v236 offset:0
    ds_read_b128 v[160:163], v236 offset:1280
    ds_read_b64_tr_b16 v[16:17], v235 offset:5760
    ds_read_b64_tr_b16 v[18:19], v235 offset:0
    ds_read_b64_tr_b16 v[20:21], v235 offset:5792
    ds_read_b64_tr_b16 v[22:23], v235 offset:32
    ds_read_b64_tr_b16 v[24:25], v235 offset:5824
    ds_read_b64_tr_b16 v[26:27], v235 offset:64
    ds_read_b128 v[164:167], v236 offset:6912
    ds_read_b128 v[168:171], v236 offset:8192
    ds_read_b64_tr_b16 v[28:29], v235 offset:11520
    ds_read_b64_tr_b16 v[30:31], v235 offset:20480
    ds_read_b64_tr_b16 v[32:33], v235 offset:11552
    ds_read_b64_tr_b16 v[34:35], v235 offset:20512
    s_waitcnt lgkmcnt(10)
    v_mfma_f32_16x16x32_bf16 v[198:201], v[16:19], v[156:159], 0
    ds_read_b64_tr_b16 v[36:37], v235 offset:11584
    ds_read_b64_tr_b16 v[38:39], v235 offset:20544
    v_mfma_f32_16x16x32_bf16 v[210:213], v[16:19], v[160:163], 0
    ds_read_b128 v[172:175], v236 offset:47104
    ds_read_b128 v[176:179], v236 offset:48384
    s_waitcnt lgkmcnt(12)
    v_mfma_f32_16x16x32_bf16 v[202:205], v[20:23], v[156:159], 0
    ds_read_b64_tr_b16 v[40:41], v11 offset:5760
    ds_read_b64_tr_b16 v[42:43], v11 offset:0
    v_mfma_f32_16x16x32_bf16 v[214:217], v[20:23], v[160:163], 0
    ds_read_b64_tr_b16 v[44:45], v11 offset:5792
    ds_read_b64_tr_b16 v[46:47], v11 offset:32
    s_waitcnt lgkmcnt(14)
    v_mfma_f32_16x16x32_bf16 v[206:209], v[24:27], v[156:159], 0
    ds_read_b64_tr_b16 v[48:49], v11 offset:5824
    ds_read_b64_tr_b16 v[50:51], v11 offset:64
    v_mfma_f32_16x16x32_bf16 v[218:221], v[24:27], v[160:163], 0
    ds_read_b128 v[180:183], v236 offset:54016
    ds_read_b128 v[184:187], v236 offset:55296
    s_waitcnt lgkmcnt(14)
    v_mfma_f32_16x16x32_bf16 v[198:201], v[28:31], v[164:167], v[198:201]
    ds_read_b64_tr_b16 v[52:53], v11 offset:11520
    ds_read_b64_tr_b16 v[54:55], v11 offset:20480
    v_mfma_f32_16x16x32_bf16 v[210:213], v[28:31], v[168:171], v[210:213]
    ds_read_b64_tr_b16 v[56:57], v11 offset:11552
    ds_read_b64_tr_b16 v[58:59], v11 offset:20512
    s_waitcnt lgkmcnt(15)
    v_mfma_f32_16x16x32_bf16 v[202:205], v[32:35], v[164:167], v[202:205]
    ds_read_b64_tr_b16 v[60:61], v11 offset:11584
    ds_read_b64_tr_b16 v[62:63], v11 offset:20544
    v_mfma_f32_16x16x32_bf16 v[214:217], v[32:35], v[168:171], v[214:217]
    s_waitcnt lgkmcnt(15)
    v_mfma_f32_16x16x32_bf16 v[206:209], v[36:39], v[164:167], v[206:209]
    v_mfma_f32_16x16x32_bf16 v[218:221], v[36:39], v[168:171], v[218:221]
    s_waitcnt lgkmcnt(12)
    v_mfma_f32_16x16x32_bf16 v[198:201], v[40:43], v[172:175], v[198:201]
    v_mfma_f32_16x16x32_bf16 v[210:213], v[40:43], v[176:179], v[210:213]
    s_waitcnt lgkmcnt(10)
    v_mfma_f32_16x16x32_bf16 v[202:205], v[44:47], v[172:175], v[202:205]
    v_mfma_f32_16x16x32_bf16 v[214:217], v[44:47], v[176:179], v[214:217]
    s_waitcnt lgkmcnt(8)
    v_mfma_f32_16x16x32_bf16 v[206:209], v[48:51], v[172:175], v[206:209]
    v_mfma_f32_16x16x32_bf16 v[218:221], v[48:51], v[176:179], v[218:221]
    s_waitcnt lgkmcnt(4)
    v_mfma_f32_16x16x32_bf16 v[198:201], v[52:55], v[180:183], v[198:201]
    v_mfma_f32_16x16x32_bf16 v[210:213], v[52:55], v[184:187], v[210:213]
    s_waitcnt lgkmcnt(2)
    v_mfma_f32_16x16x32_bf16 v[202:205], v[56:59], v[180:183], v[202:205]
    v_mfma_f32_16x16x32_bf16 v[214:217], v[56:59], v[184:187], v[214:217]
    s_waitcnt lgkmcnt(0)
    v_mfma_f32_16x16x32_bf16 v[206:209], v[60:63], v[180:183], v[206:209]
    v_mfma_f32_16x16x32_bf16 v[218:221], v[60:63], v[184:187], v[218:221]
L_b13:
    s_barrier
L_p2b:
    s_lshl_b32 s50, s37, 10
    s_setprio 3
    ds_read_b128 v[166:169], v14
    v_add_u32 v14, s50, v14
    ds_read_b128 v[172:175], v247
    ds_read_b128 v[160:163], v14
    ds_read_b64 v[164:165], v15 offset:2048
    ds_read_b64 v[180:181], v248 offset:2048
    ds_read_b64 v[12:13], v8 offset:8
    ds_read_b128 v[182:185], v249
    ds_read_b128 v[186:189], v249 offset:768
    s_add_u32 s58, s38, 6336512
    s_add_u32 s58, s58, s74
    s_add_u32 m0, s74, 45056
    v_mov_b32 v8, v247
    v_mov_b32 v9, v248
    v_mov_b32 v10, v249
    v_mov_b32 v11, 0xdddddddd
    v_mov_b32 v96, 0
    v_mov_b32 v97, 0
    v_mov_b64 v[98:99], v[96:97]
    v_mov_b64 v[100:101], v[96:97]
    v_mov_b64 v[102:103], v[96:97]
    v_mov_b64 v[104:105], v[96:97]
    v_mov_b64 v[106:107], v[96:97]
    v_mov_b64 v[108:109], v[96:97]
    v_mov_b64 v[110:111], v[96:97]
    v_mov_b64 v[128:129], v[96:97]
    v_mov_b64 v[130:131], v[96:97]
    v_mov_b64 v[132:133], v[96:97]
    v_mov_b64 v[134:135], v[96:97]
    v_mov_b64 v[136:137], v[96:97]
    v_mov_b64 v[138:139], v[96:97]
    v_mov_b64 v[140:141], v[96:97]
    v_mov_b64 v[142:143], v[96:97]
    s_waitcnt lgkmcnt(2)
    v_mfma_f32_32x32x16_bf16 v[16:31], v[172:175], v[160:163], 0
    v_mfma_f32_32x32x16_bf16 v[32:47], v[172:175], v[166:169], 0
    ds_read_b128 v[172:175], v247 offset:5632
    v_readfirstlane_b32 s48, v12
    v_readfirstlane_b32 s49, v13
    v_mov_b32 v12, 4290772991
    v_mov_b32 v13, 4290772991
    v_mov_b32 v14, 4290772991
    v_mov_b32 v15, 4290772991
    s_nop 2
    v_mfma_f32_32x32x4_2b_bf16 v[16:47], v[180:181], v[164:165], v[16:47]
    ds_read_b64 v[180:181], v248 offset:7680
    s_nop 15
    s_nop 0
    s_setprio 2
    s_waitcnt lgkmcnt(1)
    v_mfma_f32_32x32x16_bf16 v[48:63], v[172:175], v[160:163], 0
    v_exp_f32 v16, v16
    v_exp_f32 v17, v17
    v_exp_f32 v18, v18
    v_exp_f32 v19, v19
    v_exp_f32 v20, v20
    v_exp_f32 v21, v21
    v_exp_f32 v22, v22
    v_exp_f32 v23, v23
    v_exp_f32 v24, v24
    v_exp_f32 v25, v25
    v_mfma_f32_32x32x16_bf16 v[64:79], v[172:175], v[166:169], 0
    ds_read_b128 v[172:175], v8 offset:11264
    v_exp_f32 v26, v26
    v_exp_f32 v27, v27
    v_exp_f32 v28, v28
    v_exp_f32 v29, v29
    s_waitcnt lgkmcnt(1)
    v_smfmac_f32_32x32x32_bf16 v[128:143], v[182:185], v[16:23], v11
    ds_read_b128 v[190:193], v10 offset:5632
    v_exp_f32 v30, v30
    v_exp_f32 v31, v31
    v_exp_f32 v32, v32
    v_mfma_f32_32x32x4_2b_bf16 v[48:79], v[180:181], v[164:165], v[48:79]
    ds_read_b64 v[180:181], v9 offset:13312
    v_exp_f32 v33, v33
    v_exp_f32 v34, v34
    v_exp_f32 v35, v35
    v_exp_f32 v36, v36
    v_exp_f32 v37, v37
    v_exp_f32 v38, v38
    v_exp_f32 v39, v39
    v_exp_f32 v40, v40
    v_exp_f32 v41, v41
    buffer_load_dwordx4 v2, s[28:31], s58 offen sc1 lds
    s_add_u32 m0, m0, 8192
    s_add_u32 s58, s58, 8192
    v_exp_f32 v42, v42
    v_exp_f32 v43, v43
    v_smfmac_f32_32x32x32_bf16 v[128:143], v[186:189], v[24:31], v11
    ds_read_b128 v[194:197], v10 offset:6400
    v_exp_f32 v44, v44
    v_exp_f32 v45, v45
    buffer_load_dwordx4 v2, s[28:31], s58 offen sc1 lds
    s_add_u32 m0, m0, 8192
    s_add_u32 s58, s58, 8192
    v_exp_f32 v46, v46
    v_exp_f32 v47, v47
    s_setprio 1
    s_waitcnt lgkmcnt(3)
    v_mfma_f32_32x32x16_bf16 v[16:31], v[172:175], v[160:163], 0
    v_exp_f32 v48, v48
    v_exp_f32 v49, v49
    v_exp_f32 v50, v50
    v_smfmac_f32_32x32x32_bf16 v[96:111], v[182:185], v[32:39], v11
    v_exp_f32 v51, v51
    v_exp_f32 v52, v52
    v_exp_f32 v53, v53
    v_smfmac_f32_32x32x32_bf16 v[96:111], v[186:189], v[40:47], v11
    v_exp_f32 v54, v54
    v_exp_f32 v55, v55
    v_exp_f32 v56, v56
    v_exp_f32 v57, v57
    v_mfma_f32_32x32x16_bf16 v[32:47], v[172:175], v[166:169], 0
    ds_read_b128 v[172:175], v8 offset:16896
    v_exp_f32 v58, v58
    v_exp_f32 v59, v59
    v_exp_f32 v60, v60
    v_exp_f32 v61, v61
    s_waitcnt lgkmcnt(1)
    v_smfmac_f32_32x32x32_bf16 v[128:143], v[190:193], v[48:55], v11
    ds_read_b128 v[182:185], v10 offset:11264
    v_exp_f32 v62, v62
    v_exp_f32 v63, v63
    v_exp_f32 v64, v64
    v_mfma_f32_32x32x4_2b_bf16 v[16:47], v[180:181], v[164:165], v[16:47]
    ds_read_b64 v[180:181], v9 offset:18944
    v_exp_f32 v65, v65
    v_exp_f32 v66, v66
    v_exp_f32 v67, v67
    v_exp_f32 v68, v68
    v_exp_f32 v69, v69
    v_exp_f32 v70, v70
    v_exp_f32 v71, v71
    s_setprio 0
    v_exp_f32 v72, v72
    v_exp_f32 v73, v73
    buffer_load_dwordx4 v2, s[28:31], s58 offen sc1 lds
    s_add_u32 m0, m0, 8192
    s_add_u32 s58, s58, 8192
    v_exp_f32 v74, v74
    v_exp_f32 v75, v75
    v_smfmac_f32_32x32x32_bf16 v[128:143], v[194:197], v[56:63], v11
    ds_read_b128 v[186:189], v10 offset:12032
    v_exp_f32 v76, v76
    v_exp_f32 v77, v77
    buffer_load_dwordx4 v2, s[28:31], s58 offen sc1 lds
    s_add_u32 m0, m0, 8192
    s_add_u32 s58, s58, 8192
    v_exp_f32 v78, v78
    v_exp_f32 v79, v79
    s_waitcnt vmcnt(20)
    s_barrier
    s_setprio 3
    s_waitcnt lgkmcnt(3)
    v_mfma_f32_32x32x16_bf16 v[48:63], v[172:175], v[160:163], 0
    v_exp_f32 v16, v16
    v_exp_f32 v17, v17
    v_exp_f32 v18, v18
    v_smfmac_f32_32x32x32_bf16 v[96:111], v[190:193], v[64:71], v11
    v_exp_f32 v19, v19
    v_exp_f32 v20, v20
    v_exp_f32 v21, v21
    v_smfmac_f32_32x32x32_bf16 v[96:111], v[194:197], v[72:79], v11
    v_exp_f32 v22, v22
    v_exp_f32 v23, v23
    v_exp_f32 v24, v24
    v_exp_f32 v25, v25
    v_mfma_f32_32x32x16_bf16 v[64:79], v[172:175], v[166:169], 0
    ds_read_b128 v[172:175], v8 offset:22528
    v_exp_f32 v26, v26
    v_exp_f32 v27, v27
    v_exp_f32 v28, v28
    v_exp_f32 v29, v29
    s_waitcnt lgkmcnt(1)
    v_smfmac_f32_32x32x32_bf16 v[128:143], v[182:185], v[16:23], v11
    ds_read_b128 v[190:193], v10 offset:16896
    v_exp_f32 v30, v30
    v_exp_f32 v31, v31
    v_exp_f32 v32, v32
    v_mfma_f32_32x32x4_2b_bf16 v[48:79], v[180:181], v[164:165], v[48:79]
    ds_read_b64 v[180:181], v9 offset:24576
    v_exp_f32 v33, v33
    v_exp_f32 v34, v34
    v_exp_f32 v35, v35
    v_exp_f32 v36, v36
    v_exp_f32 v37, v37
    v_exp_f32 v38, v38
    v_exp_f32 v39, v39
    v_exp_f32 v40, v40
    v_exp_f32 v41, v41
    buffer_load_dwordx4 v2, s[28:31], s58 offen sc1 lds
    s_add_u32 m0, m0, 8192
    s_add_u32 s58, s58, 8192
    v_exp_f32 v42, v42
    v_exp_f32 v43, v43
    v_smfmac_f32_32x32x32_bf16 v[128:143], v[186:189], v[24:31], v11
    ds_read_b128 v[194:197], v10 offset:17664
    v_exp_f32 v44, v44
    v_exp_f32 v45, v45
    buffer_load_dwordx4 v2, s[28:31], s58 offen sc1 lds
    s_add_u32 m0, m0, 8192
    s_add_u32 s58, s58, 8192
    v_exp_f32 v46, v46
    v_exp_f32 v47, v47
    s_waitcnt lgkmcnt(3)
    v_mfma_f32_32x32x16_bf16 v[16:31], v[172:175], v[160:163], 0
    v_exp_f32 v48, v48
    v_exp_f32 v49, v49
    v_exp_f32 v50, v50
    v_smfmac_f32_32x32x32_bf16 v[96:111], v[182:185], v[32:39], v11
    v_exp_f32 v51, v51
    v_exp_f32 v52, v52
    v_exp_f32 v53, v53
    v_smfmac_f32_32x32x32_bf16 v[96:111], v[186:189], v[40:47], v11
    v_exp_f32 v54, v54
    v_exp_f32 v55, v55
    buffer_load_dwordx4 v2, s[28:31], s58 offen sc1 lds
    s_add_u32 m0, m0, 8192
    s_add_u32 s58, s58, 8192
    v_exp_f32 v56, v56
    v_exp_f32 v57, v57
    v_mfma_f32_32x32x16_bf16 v[32:47], v[172:175], v[166:169], 0
    ds_read_b128 v[172:175], v8 offset:28160
    v_exp_f32 v58, v58
    v_exp_f32 v59, v59
    v_exp_f32 v60, v60
    v_exp_f32 v61, v61
    s_waitcnt lgkmcnt(1)
    v_smfmac_f32_32x32x32_bf16 v[128:143], v[190:193], v[48:55], v11
    ds_read_b128 v[182:185], v10 offset:22528
    v_exp_f32 v62, v62
    v_exp_f32 v63, v63
    s_setprio 2
    v_exp_f32 v64, v64
    v_mfma_f32_32x32x4_2b_bf16 v[16:47], v[180:181], v[164:165], v[16:47]
    ds_read_b64 v[180:181], v9 offset:30208
    v_exp_f32 v65, v65
    v_exp_f32 v66, v66
    v_exp_f32 v67, v67
    v_exp_f32 v68, v68
    v_exp_f32 v69, v69
    v_exp_f32 v70, v70
    v_exp_f32 v71, v71
    v_exp_f32 v72, v72
    v_exp_f32 v73, v73
    buffer_load_dwordx4 v2, s[28:31], s58 offen sc1 lds
    s_add_u32 m0, m0, 8192
    s_add_u32 s58, s58, 8192
    v_exp_f32 v74, v74
    v_exp_f32 v75, v75
    v_smfmac_f32_32x32x32_bf16 v[128:143], v[194:197], v[56:63], v11
    ds_read_b128 v[186:189], v10 offset:23296
    v_exp_f32 v76, v76
    v_exp_f32 v77, v77
    buffer_load_dwordx4 v2, s[28:31], s58 offen sc1 lds
    s_add_u32 m0, m0, 8192
    s_add_u32 s58, s58, 8192
    v_exp_f32 v78, v78
    v_exp_f32 v79, v79
    s_waitcnt lgkmcnt(3)
    v_mfma_f32_32x32x16_bf16 v[48:63], v[172:175], v[160:163], 0
    v_exp_f32 v16, v16
    v_exp_f32 v17, v17
    v_exp_f32 v18, v18
    v_smfmac_f32_32x32x32_bf16 v[96:111], v[190:193], v[64:71], v11
    v_exp_f32 v19, v19
    v_exp_f32 v20, v20
    v_exp_f32 v21, v21
    v_smfmac_f32_32x32x32_bf16 v[96:111], v[194:197], v[72:79], v11
    v_exp_f32 v22, v22
    v_exp_f32 v23, v23
    s_setprio 1
    buffer_load_dwordx4 v2, s[28:31], s58 offen sc1 lds
    s_add_u32 m0, m0, 8192
    s_add_u32 s58, s58, 8192
    v_exp_f32 v24, v24
    v_exp_f32 v25, v25
    v_mfma_f32_32x32x16_bf16 v[64:79], v[172:175], v[166:169], 0
    ds_read_b128 v[172:175], v8 offset:33792
    v_exp_f32 v26, v26
    v_exp_f32 v27, v27
    v_exp_f32 v28, v28
    v_exp_f32 v29, v29
    s_waitcnt lgkmcnt(1)
    v_smfmac_f32_32x32x32_bf16 v[128:143], v[182:185], v[16:23], v11
    ds_read_b128 v[190:193], v10 offset:28160
    v_exp_f32 v30, v30
    v_exp_f32 v31, v31
    v_exp_f32 v32, v32
    v_mfma_f32_32x32x4_2b_bf16 v[48:79], v[180:181], v[164:165], v[48:79]
    ds_read_b64 v[180:181], v9 offset:35840
    v_exp_f32 v33, v33
    v_exp_f32 v34, v34
    v_exp_f32 v35, v35
    v_exp_f32 v36, v36
    v_exp_f32 v37, v37
    v_exp_f32 v38, v38
    v_exp_f32 v39, v39
    s_setprio 0
    v_exp_f32 v40, v40
    v_exp_f32 v41, v41
    buffer_load_dwordx4 v2, s[28:31], s58 offen sc1 lds
    s_add_u32 m0, m0, 8192
    s_add_u32 s58, s58, 8192
    v_exp_f32 v42, v42
    v_exp_f32 v43, v43
    v_smfmac_f32_32x32x32_bf16 v[128:143], v[186:189], v[24:31], v11
    ds_read_b128 v[194:197], v10 offset:28928
    v_exp_f32 v44, v44
    v_exp_f32 v45, v45
    buffer_load_dwordx4 v2, s[28:31], s58 offen sc1 lds
    s_add_u32 m0, m0, 8192
    s_add_u32 s58, s58, 8192
    v_exp_f32 v46, v46
    v_exp_f32 v47, v47
    s_waitcnt vmcnt(7)
    s_barrier
    s_setprio 3
    s_waitcnt lgkmcnt(3)
    v_mfma_f32_32x32x16_bf16 v[16:31], v[172:175], v[160:163], 0
    v_exp_f32 v48, v48
    v_exp_f32 v49, v49
    v_exp_f32 v50, v50
    v_smfmac_f32_32x32x32_bf16 v[96:111], v[182:185], v[32:39], v11
    v_exp_f32 v51, v51
    v_exp_f32 v52, v52
    v_exp_f32 v53, v53
    buffer_store_dwordx4 v[12:15], v245, s[28:31], s71 offen offset:0 sc1
    v_smfmac_f32_32x32x32_bf16 v[96:111], v[186:189], v[40:47], v11
    v_exp_f32 v54, v54
    v_exp_f32 v55, v55
    v_exp_f32 v56, v56
    v_exp_f32 v57, v57
    buffer_store_dwordx4 v[198:201], v241, s[28:31], s75 offen sc1
    s_add_u32 s75, s75, s76
    v_mfma_f32_32x32x16_bf16 v[32:47], v[172:175], v[166:169], 0
    ds_read_b128 v[172:175], v8 offset:39424
    v_exp_f32 v58, v58
    v_exp_f32 v59, v59
    v_exp_f32 v60, v60
    v_exp_f32 v61, v61
    s_waitcnt lgkmcnt(1)
    v_smfmac_f32_32x32x32_bf16 v[128:143], v[190:193], v[48:55], v11
    ds_read_b128 v[182:185], v10 offset:33792
    v_exp_f32 v62, v62
    v_exp_f32 v63, v63
    v_exp_f32 v64, v64
    v_mfma_f32_32x32x4_2b_bf16 v[16:47], v[180:181], v[164:165], v[16:47]
    ds_read_b64 v[180:181], v9 offset:41472
    v_exp_f32 v65, v65
    v_exp_f32 v66, v66
    v_exp_f32 v67, v67
    v_exp_f32 v68, v68
    v_exp_f32 v69, v69
    v_exp_f32 v70, v70
    v_exp_f32 v71, v71
    v_exp_f32 v72, v72
    v_exp_f32 v73, v73
    buffer_store_dwordx4 v[202:205], v241, s[28:31], s75 offen sc1
    s_add_u32 s75, s75, s76
    buffer_load_dwordx4 v2, s[28:31], s58 offen sc1 lds
    s_add_u32 m0, m0, 8192
    s_add_u32 s58, s58, 8192
    v_exp_f32 v74, v74
    v_exp_f32 v75, v75
    v_smfmac_f32_32x32x32_bf16 v[128:143], v[194:197], v[56:63], v11
    ds_read_b128 v[186:189], v10 offset:34560
    v_exp_f32 v76, v76
    v_exp_f32 v77, v77
    v_exp_f32 v78, v78
    v_exp_f32 v79, v79
    s_waitcnt lgkmcnt(3)
    v_mfma_f32_32x32x16_bf16 v[48:63], v[172:175], v[160:163], 0
    v_exp_f32 v16, v16
    v_exp_f32 v17, v17
    v_exp_f32 v18, v18
    v_smfmac_f32_32x32x32_bf16 v[96:111], v[190:193], v[64:71], v11
    v_exp_f32 v19, v19
    v_exp_f32 v20, v20
    v_exp_f32 v21, v21
    v_smfmac_f32_32x32x32_bf16 v[96:111], v[194:197], v[72:79], v11
    v_exp_f32 v22, v22
    v_exp_f32 v23, v23
    v_exp_f32 v24, v24
    v_exp_f32 v25, v25
    buffer_store_dwordx4 v[206:209], v241, s[28:31], s75 offen sc1
    s_add_u32 s75, s75, s76
    v_mfma_f32_32x32x16_bf16 v[64:79], v[172:175], v[166:169], 0
    ds_read_b128 v[172:175], v8 offset:45056
    v_exp_f32 v26, v26
    v_exp_f32 v27, v27
    v_exp_f32 v28, v28
    v_exp_f32 v29, v29
    s_waitcnt lgkmcnt(1)
    v_smfmac_f32_32x32x32_bf16 v[128:143], v[182:185], v[16:23], v11
    ds_read_b128 v[190:193], v10 offset:39424
    v_exp_f32 v30, v30
    v_exp_f32 v31, v31
    v_exp_f32 v32, v32
    v_mfma_f32_32x32x4_2b_bf16 v[48:79], v[180:181], v[164:165], v[48:79]
    ds_read_b64 v[180:181], v9 offset:47104
    v_exp_f32 v33, v33
    v_exp_f32 v34, v34
    v_exp_f32 v35, v35
    v_exp_f32 v36, v36
    v_exp_f32 v37, v37
    v_exp_f32 v38, v38
    v_exp_f32 v39, v39
    v_exp_f32 v40, v40
    v_exp_f32 v41, v41
    v_or_b32 v241, v255, v241
    buffer_store_dwordx4 v[210:213], v241, s[28:31], s75 offen sc1
    s_add_u32 s75, s75, s76
    v_exp_f32 v42, v42
    v_exp_f32 v43, v43
    v_smfmac_f32_32x32x32_bf16 v[128:143], v[186:189], v[24:31], v11
    ds_read_b128 v[194:197], v10 offset:40192
    v_exp_f32 v44, v44
    v_exp_f32 v45, v45
    v_exp_f32 v46, v46
    v_exp_f32 v47, v47
    s_waitcnt lgkmcnt(3)
    v_mfma_f32_32x32x16_bf16 v[16:31], v[172:175], v[160:163], 0
    v_exp_f32 v48, v48
    v_exp_f32 v49, v49
    v_exp_f32 v50, v50
    v_smfmac_f32_32x32x32_bf16 v[96:111], v[182:185], v[32:39], v11
    v_exp_f32 v51, v51
    v_exp_f32 v52, v52
    v_exp_f32 v53, v53
    buffer_store_dwordx4 v[12:15], v245, s[28:31], s71 offen offset:1024 sc1
    v_smfmac_f32_32x32x32_bf16 v[96:111], v[186:189], v[40:47], v11
    v_exp_f32 v54, v54
    v_exp_f32 v55, v55
    v_exp_f32 v56, v56
    v_exp_f32 v57, v57
    buffer_store_dwordx4 v[214:217], v241, s[28:31], s75 offen sc1
    s_add_u32 s75, s75, s76
    v_mfma_f32_32x32x16_bf16 v[32:47], v[172:175], v[166:169], 0
    ds_read_b128 v[172:175], v8 offset:50688
    v_exp_f32 v58, v58
    v_exp_f32 v59, v59
    v_exp_f32 v60, v60
    v_exp_f32 v61, v61
    s_waitcnt lgkmcnt(1)
    v_smfmac_f32_32x32x32_bf16 v[128:143], v[190:193], v[48:55], v11
    ds_read_b128 v[182:185], v10 offset:45056
    v_exp_f32 v62, v62
    v_exp_f32 v63, v63
    v_exp_f32 v64, v64
    v_mfma_f32_32x32x4_2b_bf16 v[16:47], v[180:181], v[164:165], v[16:47]
    ds_read_b64 v[180:181], v9 offset:52736
    v_exp_f32 v65, v65
    v_exp_f32 v66, v66
    v_exp_f32 v67, v67
    v_exp_f32 v68, v68
    v_exp_f32 v69, v69
    v_exp_f32 v70, v70
    v_exp_f32 v71, v71
    v_exp_f32 v72, v72
    v_exp_f32 v73, v73
    buffer_store_dwordx4 v[218:221], v241, s[28:31], s75 offen sc1
    s_add_u32 s75, s75, s76
    v_exp_f32 v74, v74
    v_exp_f32 v75, v75
    v_smfmac_f32_32x32x32_bf16 v[128:143], v[194:197], v[56:63], v11
    ds_read_b128 v[186:189], v10 offset:45824
    v_exp_f32 v76, v76
    v_exp_f32 v77, v77
    v_exp_f32 v78, v78
    v_exp_f32 v79, v79
    s_waitcnt lgkmcnt(3)
    v_mfma_f32_32x32x16_bf16 v[48:63], v[172:175], v[160:163], 0
    v_exp_f32 v16, v16
    v_exp_f32 v17, v17
    v_exp_f32 v18, v18
    v_smfmac_f32_32x32x32_bf16 v[96:111], v[190:193], v[64:71], v11
    v_exp_f32 v19, v19
    v_exp_f32 v20, v20
    v_exp_f32 v21, v21
    v_smfmac_f32_32x32x32_bf16 v[96:111], v[194:197], v[72:79], v11
    v_exp_f32 v22, v22
    v_exp_f32 v23, v23
    v_exp_f32 v24, v24
    v_exp_f32 v25, v25
    v_or_b32 v241, s79, v241
    buffer_store_dwordx4 v[222:225], v241, s[28:31], s75 offen sc1
    s_add_u32 s75, s75, s76
    v_mfma_f32_32x32x16_bf16 v[64:79], v[172:175], v[166:169], 0
    ds_read_b128 v[172:175], v8 offset:56320
    v_exp_f32 v26, v26
    v_exp_f32 v27, v27
    v_exp_f32 v28, v28
    v_exp_f32 v29, v29
    s_waitcnt lgkmcnt(1)
    v_smfmac_f32_32x32x32_bf16 v[128:143], v[182:185], v[16:23], v11
    ds_read_b128 v[190:193], v10 offset:50688
    v_exp_f32 v30, v30
    v_exp_f32 v31, v31
    v_exp_f32 v32, v32
    v_mfma_f32_32x32x4_2b_bf16 v[48:79], v[180:181], v[164:165], v[48:79]
    ds_read_b64 v[180:181], v9 offset:58368
    v_exp_f32 v33, v33
    v_exp_f32 v34, v34
    v_exp_f32 v35, v35
    v_exp_f32 v36, v36
    v_exp_f32 v37, v37
    v_exp_f32 v38, v38
    v_exp_f32 v39, v39
    v_exp_f32 v40, v40
    v_exp_f32 v41, v41
    buffer_store_dwordx4 v[226:229], v241, s[28:31], s75 offen sc1
    s_add_u32 s75, s75, s76
    v_exp_f32 v42, v42
    v_exp_f32 v43, v43
    v_smfmac_f32_32x32x32_bf16 v[128:143], v[186:189], v[24:31], v11
    ds_read_b128 v[194:197], v10 offset:51456
    v_exp_f32 v44, v44
    v_exp_f32 v45, v45
    v_exp_f32 v46, v46
    v_exp_f32 v47, v47
    s_setprio 2
    s_waitcnt lgkmcnt(3)
    v_mfma_f32_32x32x16_bf16 v[16:31], v[172:175], v[160:163], 0
    v_exp_f32 v48, v48
    v_exp_f32 v49, v49
    v_exp_f32 v50, v50
    v_smfmac_f32_32x32x32_bf16 v[96:111], v[182:185], v[32:39], v11
    v_exp_f32 v51, v51
    v_exp_f32 v52, v52
    v_exp_f32 v53, v53
    buffer_store_dwordx4 v[12:15], v245, s[28:31], s71 offen offset:1536 sc1
    v_smfmac_f32_32x32x32_bf16 v[96:111], v[186:189], v[40:47], v11
    v_exp_f32 v54, v54
    v_exp_f32 v55, v55
    v_exp_f32 v56, v56
    v_exp_f32 v57, v57
    buffer_store_dwordx4 v[230:233], v241, s[28:31], s75 offen sc1
    s_add_u32 s75, s75, s76
    v_mfma_f32_32x32x16_bf16 v[32:47], v[172:175], v[166:169], 0
    ds_read_b128 v[172:175], v8 offset:61952
    v_exp_f32 v58, v58
    v_exp_f32 v59, v59
    v_exp_f32 v60, v60
    v_exp_f32 v61, v61
    s_waitcnt lgkmcnt(1)
    v_smfmac_f32_32x32x32_bf16 v[128:143], v[190:193], v[48:55], v11
    ds_read_b128 v[182:185], v10 offset:56320
    v_exp_f32 v62, v62
    v_exp_f32 v63, v63
    v_exp_f32 v64, v64
    v_mfma_f32_32x32x4_2b_bf16 v[16:47], v[180:181], v[164:165], v[16:47]
    ds_read_b64 v[180:181], v9 offset:64000
    v_exp_f32 v65, v65
    v_exp_f32 v66, v66
    v_exp_f32 v67, v67
    v_exp_f32 v68, v68
    v_exp_f32 v69, v69
    v_exp_f32 v70, v70
    v_exp_f32 v71, v71
    v_exp_f32 v72, v72
    v_exp_f32 v73, v73
    buffer_store_dwordx4 v[234:237], v241, s[28:31], s75 offen sc1
    s_add_u32 s75, s75, s76
    v_exp_f32 v74, v74
    v_exp_f32 v75, v75
    v_smfmac_f32_32x32x32_bf16 v[128:143], v[194:197], v[56:63], v11
    ds_read_b128 v[186:189], v10 offset:57088
    v_exp_f32 v76, v76
    v_exp_f32 v77, v77
    v_exp_f32 v78, v78
    v_exp_f32 v79, v79
    s_waitcnt lgkmcnt(3)
    v_mfma_f32_32x32x16_bf16 v[48:63], v[172:175], v[160:163], 0
    v_exp_f32 v16, v16
    v_exp_f32 v17, v17
    v_exp_f32 v18, v18
    v_smfmac_f32_32x32x32_bf16 v[96:111], v[190:193], v[64:71], v11
    v_exp_f32 v19, v19
    v_exp_f32 v20, v20
    v_exp_f32 v21, v21
    v_smfmac_f32_32x32x32_bf16 v[96:111], v[194:197], v[72:79], v11
    v_exp_f32 v22, v22
    v_exp_f32 v23, v23
    v_exp_f32 v24, v24
    v_exp_f32 v25, v25
    v_mfma_f32_32x32x16_bf16 v[64:79], v[172:175], v[166:169], 0
    v_add_u32 v8, 61952, v8
    ds_read_b128 v[172:175], v8 offset:5632
    v_exp_f32 v26, v26
    v_exp_f32 v27, v27
    v_exp_f32 v28, v28
    s_cmp_eq_u32 s78, 0
    s_cbranch_scc1 L_g1b
    s_waitcnt vmcnt(0)
    v_lshl_or_b32 v198, v207, 16, v206
    v_lshl_or_b32 v199, v209, 16, v208
    v_lshl_or_b32 v200, v211, 16, v210
    v_lshl_or_b32 v201, v213, 16, v212
    v_lshl_or_b32 v202, v215, 16, v214
    v_lshl_or_b32 v203, v217, 16, v216
    v_lshl_or_b32 v204, v219, 16, v218
    v_lshl_or_b32 v205, v221, 16, v220
    buffer_store_dwordx4 v[198:201], v2, s[28:31], s75 offen sc1
    s_add_u32 s75, s75, 1048576
    buffer_store_dwordx4 v[202:205], v114, s[28:31], s75 offen sc1
    buffer_store_dwordx2 v[238:239], v246, s[28:31], s53 offen sc1
L_g1b:
    v_exp_f32 v29, v29
    s_waitcnt lgkmcnt(1)
    v_smfmac_f32_32x32x32_bf16 v[128:143], v[182:185], v[16:23], v11
    ds_read_b128 v[190:193], v10 offset:61952
    v_exp_f32 v30, v30
    v_exp_f32 v31, v31
    v_exp_f32 v32, v32
    v_mfma_f32_32x32x4_2b_bf16 v[48:79], v[180:181], v[164:165], v[48:79]
    v_add_u32 v9, 61952, v9
    ds_read_b64 v[180:181], v9 offset:7680
    v_exp_f32 v33, v33
    v_exp_f32 v34, v34
    v_exp_f32 v35, v35
    v_exp_f32 v36, v36
    v_exp_f32 v37, v37
    v_exp_f32 v38, v38
    v_exp_f32 v39, v39
    v_exp_f32 v40, v40
    v_exp_f32 v41, v41
    v_exp_f32 v42, v42
    v_exp_f32 v43, v43
    v_smfmac_f32_32x32x32_bf16 v[128:143], v[186:189], v[24:31], v11
    ds_read_b128 v[194:197], v10 offset:62720
    v_exp_f32 v44, v44
    v_exp_f32 v45, v45
    v_exp_f32 v46, v46
    v_exp_f32 v47, v47
    s_setprio 1
    s_waitcnt lgkmcnt(3)
    v_mfma_f32_32x32x16_bf16 v[16:31], v[172:175], v[160:163], 0
    v_exp_f32 v48, v48
    v_exp_f32 v49, v49
    v_exp_f32 v50, v50
    v_smfmac_f32_32x32x32_bf16 v[96:111], v[182:185], v[32:39], v11
    v_exp_f32 v51, v51
    v_exp_f32 v52, v52
    v_exp_f32 v53, v53
    v_smfmac_f32_32x32x32_bf16 v[96:111], v[186:189], v[40:47], v11
    v_exp_f32 v54, v54
    v_exp_f32 v55, v55
    v_exp_f32 v56, v56
    v_exp_f32 v57, v57
    v_mfma_f32_32x32x16_bf16 v[32:47], v[172:175], v[166:169], 0
    ds_read_b128 v[172:175], v8 offset:11264
    v_exp_f32 v58, v58
    v_exp_f32 v59, v59
    v_exp_f32 v60, v60
    v_exp_f32 v61, v61
    s_waitcnt lgkmcnt(1)
    v_smfmac_f32_32x32x32_bf16 v[128:143], v[190:193], v[48:55], v11
    v_add_u32 v10, 61952, v10
    ds_read_b128 v[182:185], v10 offset:5632
    v_exp_f32 v62, v62
    v_exp_f32 v63, v63
    v_exp_f32 v64, v64
    v_mfma_f32_32x32x4_2b_bf16 v[16:47], v[180:181], v[164:165], v[16:47]
    ds_read_b64 v[180:181], v9 offset:13312
    v_exp_f32 v65, v65
    v_exp_f32 v66, v66
    v_exp_f32 v67, v67
    v_exp_f32 v68, v68
    v_exp_f32 v69, v69
    v_exp_f32 v70, v70
    v_exp_f32 v71, v71
    s_setprio 0
    v_exp_f32 v72, v72
    v_exp_f32 v73, v73
    v_exp_f32 v74, v74
    v_exp_f32 v75, v75
    v_smfmac_f32_32x32x32_bf16 v[128:143], v[194:197], v[56:63], v11
    ds_read_b128 v[186:189], v10 offset:6400
    v_exp_f32 v76, v76
    v_exp_f32 v77, v77
    v_exp_f32 v78, v78
    v_exp_f32 v79, v79
    s_add_u32 s58, s38, 6426624
    s_add_u32 s58, s58, s74
    s_add_u32 m0, s74, 0
    v_mov_b32 v80, s48
    v_mov_b32 v81, s49
    v_mov_b32 v82, s73
    s_waitcnt vmcnt(0)
    s_barrier
    s_mov_b64 exec, 1
    buffer_store_dwordx2 v[80:81], v82, s[28:31], s72 offen sc1
    s_mov_b64 exec, -1
    s_setprio 3
    s_waitcnt lgkmcnt(3)
    v_mfma_f32_32x32x16_bf16 v[48:63], v[172:175], v[160:163], 0
    v_exp_f32 v16, v16
    v_exp_f32 v17, v17
    v_exp_f32 v18, v18
    v_smfmac_f32_32x32x32_bf16 v[96:111], v[190:193], v[64:71], v11
    v_exp_f32 v19, v19
    v_exp_f32 v20, v20
    v_exp_f32 v21, v21
    v_smfmac_f32_32x32x32_bf16 v[96:111], v[194:197], v[72:79], v11
    v_exp_f32 v22, v22
    v_exp_f32 v23, v23
    v_exp_f32 v24, v24
    v_exp_f32 v25, v25
    v_mfma_f32_32x32x16_bf16 v[64:79], v[172:175], v[166:169], 0
    ds_read_b128 v[172:175], v8 offset:16896
    v_exp_f32 v26, v26
    v_exp_f32 v27, v27
    v_exp_f32 v28, v28
    v_exp_f32 v29, v29
    s_waitcnt lgkmcnt(1)
    v_smfmac_f32_32x32x32_bf16 v[128:143], v[182:185], v[16:23], v11
    ds_read_b128 v[190:193], v10 offset:11264
    v_exp_f32 v30, v30
    v_exp_f32 v31, v31
    v_exp_f32 v32, v32
    v_mfma_f32_32x32x4_2b_bf16 v[48:79], v[180:181], v[164:165], v[48:79]
    ds_read_b64 v[180:181], v9 offset:18944
    v_exp_f32 v33, v33
    v_exp_f32 v34, v34
    v_exp_f32 v35, v35
    v_exp_f32 v36, v36
    v_exp_f32 v37, v37
    v_exp_f32 v38, v38
    v_exp_f32 v39, v39
    v_exp_f32 v40, v40
    v_exp_f32 v41, v41
    v_exp_f32 v42, v42
    v_exp_f32 v43, v43
    v_smfmac_f32_32x32x32_bf16 v[128:143], v[186:189], v[24:31], v11
    ds_read_b128 v[194:197], v10 offset:12032
    v_exp_f32 v44, v44
    v_exp_f32 v45, v45
    v_exp_f32 v46, v46
    v_exp_f32 v47, v47
    s_waitcnt lgkmcnt(3)
    v_mfma_f32_32x32x16_bf16 v[16:31], v[172:175], v[160:163], 0
    v_exp_f32 v48, v48
    v_exp_f32 v49, v49
    v_exp_f32 v50, v50
    v_smfmac_f32_32x32x32_bf16 v[96:111], v[182:185], v[32:39], v11
    v_exp_f32 v51, v51
    v_exp_f32 v52, v52
    v_exp_f32 v53, v53
    v_smfmac_f32_32x32x32_bf16 v[96:111], v[186:189], v[40:47], v11
    v_exp_f32 v54, v54
    v_exp_f32 v55, v55
    v_exp_f32 v56, v56
    v_exp_f32 v57, v57
    v_mfma_f32_32x32x16_bf16 v[32:47], v[172:175], v[166:169], 0
    ds_read_b128 v[172:175], v8 offset:22528
    v_exp_f32 v58, v58
    v_exp_f32 v59, v59
    v_exp_f32 v60, v60
    v_exp_f32 v61, v61
    s_waitcnt lgkmcnt(1)
    v_smfmac_f32_32x32x32_bf16 v[128:143], v[190:193], v[48:55], v11
    ds_read_b128 v[182:185], v10 offset:16896
    v_exp_f32 v62, v62
    v_exp_f32 v63, v63
    v_exp_f32 v64, v64
    v_mfma_f32_32x32x4_2b_bf16 v[16:47], v[180:181], v[164:165], v[16:47]
    ds_read_b64 v[180:181], v9 offset:24576
    v_exp_f32 v65, v65
    v_exp_f32 v66, v66
    v_exp_f32 v67, v67
    v_exp_f32 v68, v68
    v_exp_f32 v69, v69
    v_exp_f32 v70, v70
    v_exp_f32 v71, v71
    v_exp_f32 v72, v72
    v_exp_f32 v73, v73
    buffer_load_dwordx4 v2, s[28:31], s58 offen sc1 lds
    s_add_u32 m0, m0, 8192
    s_add_u32 s58, s58, 8192
    v_exp_f32 v74, v74
    v_exp_f32 v75, v75
    v_smfmac_f32_32x32x32_bf16 v[128:143], v[194:197], v[56:63], v11
    ds_read_b128 v[186:189], v10 offset:17664
    v_exp_f32 v76, v76
    v_exp_f32 v77, v77
    buffer_load_dwordx4 v2, s[28:31], s58 offen sc1 lds
    s_add_u32 m0, m0, 8192
    s_add_u32 s58, s58, 8192
    v_exp_f32 v78, v78
    v_exp_f32 v79, v79
    s_waitcnt lgkmcnt(3)
    v_mfma_f32_32x32x16_bf16 v[48:63], v[172:175], v[160:163], 0
    v_exp_f32 v16, v16
    v_exp_f32 v17, v17
    v_exp_f32 v18, v18
    v_smfmac_f32_32x32x32_bf16 v[96:111], v[190:193], v[64:71], v11
    v_exp_f32 v19, v19
    v_exp_f32 v20, v20
    v_exp_f32 v21, v21
    v_smfmac_f32_32x32x32_bf16 v[96:111], v[194:197], v[72:79], v11
    v_exp_f32 v22, v22
    v_exp_f32 v23, v23
    v_exp_f32 v24, v24
    v_exp_f32 v25, v25
    v_mfma_f32_32x32x16_bf16 v[64:79], v[172:175], v[166:169], 0
    ds_read_b128 v[172:175], v8 offset:28160
    v_exp_f32 v26, v26
    v_exp_f32 v27, v27
    v_exp_f32 v28, v28
    v_exp_f32 v29, v29
    s_waitcnt lgkmcnt(1)
    v_smfmac_f32_32x32x32_bf16 v[128:143], v[182:185], v[16:23], v11
    ds_read_b128 v[190:193], v10 offset:22528
    v_exp_f32 v30, v30
    v_exp_f32 v31, v31
    v_exp_f32 v32, v32
    v_mfma_f32_32x32x4_2b_bf16 v[48:79], v[180:181], v[164:165], v[48:79]
    ds_read_b64 v[180:181], v9 offset:30208
    v_exp_f32 v33, v33
    v_exp_f32 v34, v34
    v_exp_f32 v35, v35
    v_exp_f32 v36, v36
    v_exp_f32 v37, v37
    v_exp_f32 v38, v38
    v_exp_f32 v39, v39
    v_exp_f32 v40, v40
    v_exp_f32 v41, v41
    buffer_load_dwordx4 v2, s[28:31], s58 offen sc1 lds
    s_add_u32 m0, m0, 8192
    s_add_u32 s58, s58, 8192
    v_exp_f32 v42, v42
    v_exp_f32 v43, v43
    v_smfmac_f32_32x32x32_bf16 v[128:143], v[186:189], v[24:31], v11
    ds_read_b128 v[194:197], v10 offset:23296
    v_exp_f32 v44, v44
    v_exp_f32 v45, v45
    buffer_load_dwordx4 v2, s[28:31], s58 offen sc1 lds
    s_add_u32 m0, m0, 8192
    s_add_u32 s58, s58, 8192
    v_exp_f32 v46, v46
    v_exp_f32 v47, v47
    s_waitcnt lgkmcnt(3)
    v_mfma_f32_32x32x16_bf16 v[16:31], v[172:175], v[160:163], 0
    v_exp_f32 v48, v48
    v_exp_f32 v49, v49
    v_exp_f32 v50, v50
    v_smfmac_f32_32x32x32_bf16 v[96:111], v[182:185], v[32:39], v11
    v_exp_f32 v51, v51
    v_exp_f32 v52, v52
    v_exp_f32 v53, v53
    v_smfmac_f32_32x32x32_bf16 v[96:111], v[186:189], v[40:47], v11
    v_exp_f32 v54, v54
    v_exp_f32 v55, v55
    v_exp_f32 v56, v56
    v_exp_f32 v57, v57
    v_mfma_f32_32x32x16_bf16 v[32:47], v[172:175], v[166:169], 0
    ds_read_b128 v[172:175], v8 offset:33792
    v_exp_f32 v58, v58
    v_exp_f32 v59, v59
    v_exp_f32 v60, v60
    v_exp_f32 v61, v61
    s_waitcnt lgkmcnt(1)
    v_smfmac_f32_32x32x32_bf16 v[128:143], v[190:193], v[48:55], v11
    ds_read_b128 v[182:185], v10 offset:28160
    v_exp_f32 v62, v62
    v_exp_f32 v63, v63
    v_exp_f32 v64, v64
    v_mfma_f32_32x32x4_2b_bf16 v[16:47], v[180:181], v[164:165], v[16:47]
    ds_read_b64 v[180:181], v9 offset:35840
    v_exp_f32 v65, v65
    v_exp_f32 v66, v66
    v_exp_f32 v67, v67
    v_exp_f32 v68, v68
    v_exp_f32 v69, v69
    v_exp_f32 v70, v70
    v_exp_f32 v71, v71
    v_exp_f32 v72, v72
    v_exp_f32 v73, v73
    buffer_load_dwordx4 v2, s[28:31], s58 offen sc1 lds
    s_add_u32 m0, m0, 8192
    s_add_u32 s58, s58, 8192
    v_exp_f32 v74, v74
    v_exp_f32 v75, v75
    v_smfmac_f32_32x32x32_bf16 v[128:143], v[194:197], v[56:63], v11
    ds_read_b128 v[186:189], v10 offset:28928
    v_exp_f32 v76, v76
    v_exp_f32 v77, v77
    buffer_load_dwordx4 v2, s[28:31], s58 offen sc1 lds
    s_add_u32 m0, m0, 8192
    s_add_u32 s58, s58, 8192
    v_exp_f32 v78, v78
    v_exp_f32 v79, v79
    s_setprio 2
    s_waitcnt lgkmcnt(3)
    v_mfma_f32_32x32x16_bf16 v[48:63], v[172:175], v[160:163], 0
    v_exp_f32 v16, v16
    v_exp_f32 v17, v17
    v_exp_f32 v18, v18
    v_smfmac_f32_32x32x32_bf16 v[96:111], v[190:193], v[64:71], v11
    v_exp_f32 v19, v19
    v_exp_f32 v20, v20
    v_exp_f32 v21, v21
    v_smfmac_f32_32x32x32_bf16 v[96:111], v[194:197], v[72:79], v11
    v_exp_f32 v22, v22
    v_exp_f32 v23, v23
    v_exp_f32 v24, v24
    v_exp_f32 v25, v25
    v_mfma_f32_32x32x16_bf16 v[64:79], v[172:175], v[166:169], 0
    ds_read_b128 v[172:175], v8 offset:39424
    v_exp_f32 v26, v26
    v_exp_f32 v27, v27
    v_exp_f32 v28, v28
    v_exp_f32 v29, v29
    s_waitcnt lgkmcnt(1)
    v_smfmac_f32_32x32x32_bf16 v[128:143], v[182:185], v[16:23], v11
    ds_read_b128 v[190:193], v10 offset:33792
    v_exp_f32 v30, v30
    v_exp_f32 v31, v31
    v_exp_f32 v32, v32
    v_mfma_f32_32x32x4_2b_bf16 v[48:79], v[180:181], v[164:165], v[48:79]
    ds_read_b64 v[180:181], v9 offset:41472
    v_exp_f32 v33, v33
    v_exp_f32 v34, v34
    v_exp_f32 v35, v35
    v_exp_f32 v36, v36
    v_exp_f32 v37, v37
    v_exp_f32 v38, v38
    v_exp_f32 v39, v39
    v_exp_f32 v40, v40
    v_exp_f32 v41, v41
    v_exp_f32 v42, v42
    v_exp_f32 v43, v43
    v_smfmac_f32_32x32x32_bf16 v[128:143], v[186:189], v[24:31], v11
    ds_read_b128 v[194:197], v10 offset:34560
    v_exp_f32 v44, v44
    v_exp_f32 v45, v45
    v_exp_f32 v46, v46
    v_exp_f32 v47, v47
    s_mov_b32 s50, 29458432
    buffer_load_dwordx2 v[14:15], v240, s[28:31], s50 offen sc1
    s_waitcnt lgkmcnt(3)
    v_mfma_f32_32x32x16_bf16 v[16:31], v[172:175], v[160:163], 0
    v_exp_f32 v48, v48
    v_exp_f32 v49, v49
    v_exp_f32 v50, v50
    v_smfmac_f32_32x32x32_bf16 v[96:111], v[182:185], v[32:39], v11
    v_exp_f32 v51, v51
    v_exp_f32 v52, v52
    v_exp_f32 v53, v53
    v_smfmac_f32_32x32x32_bf16 v[96:111], v[186:189], v[40:47], v11
    v_exp_f32 v54, v54
    v_exp_f32 v55, v55
    v_exp_f32 v56, v56
    v_exp_f32 v57, v57
    v_mfma_f32_32x32x16_bf16 v[32:47], v[172:175], v[166:169], 0
    ds_read_b128 v[172:175], v8 offset:45056
    v_exp_f32 v58, v58
    v_exp_f32 v59, v59
    v_exp_f32 v60, v60
    v_exp_f32 v61, v61
    s_waitcnt lgkmcnt(1)
    v_smfmac_f32_32x32x32_bf16 v[128:143], v[190:193], v[48:55], v11
    ds_read_b128 v[182:185], v10 offset:39424
    v_exp_f32 v62, v62
    v_exp_f32 v63, v63
    v_exp_f32 v64, v64
    v_mfma_f32_32x32x4_2b_bf16 v[16:47], v[180:181], v[164:165], v[16:47]
    ds_read_b64 v[180:181], v9 offset:47104
    v_exp_f32 v65, v65
    v_exp_f32 v66, v66
    v_exp_f32 v67, v67
    v_exp_f32 v68, v68
    v_exp_f32 v69, v69
    v_exp_f32 v70, v70
    v_exp_f32 v71, v71
    v_exp_f32 v72, v72
    v_exp_f32 v73, v73
    v_exp_f32 v74, v74
    v_exp_f32 v75, v75
    v_smfmac_f32_32x32x32_bf16 v[128:143], v[194:197], v[56:63], v11
    ds_read_b128 v[186:189], v10 offset:40192
    v_exp_f32 v76, v76
    v_exp_f32 v77, v77
    v_exp_f32 v78, v78
    v_exp_f32 v79, v79
    s_waitcnt lgkmcnt(3)
    v_mfma_f32_32x32x16_bf16 v[48:63], v[172:175], v[160:163], 0
    v_exp_f32 v16, v16
    v_exp_f32 v17, v17
    v_exp_f32 v18, v18
    v_smfmac_f32_32x32x32_bf16 v[96:111], v[190:193], v[64:71], v11
    v_exp_f32 v19, v19
    v_exp_f32 v20, v20
    v_exp_f32 v21, v21
    v_smfmac_f32_32x32x32_bf16 v[96:111], v[194:197], v[72:79], v11
    v_exp_f32 v22, v22
    v_exp_f32 v23, v23
    v_exp_f32 v24, v24
    v_exp_f32 v25, v25
    s_waitcnt vmcnt(0)
    v_cmp_ne_u64 vcc, s[48:49], v[14:15]
    s_cbranch_vccnz L_o7
L_a7:
    v_mfma_f32_32x32x16_bf16 v[64:79], v[172:175], v[166:169], 0
    ds_read_b128 v[172:175], v8 offset:50688
    v_exp_f32 v26, v26
    v_exp_f32 v27, v27
    buffer_load_dwordx4 v[230:233], v242, s[28:31], s66 offen sc1
    v_exp_f32 v28, v28
    v_exp_f32 v29, v29
    s_waitcnt lgkmcnt(1)
    v_smfmac_f32_32x32x32_bf16 v[128:143], v[182:185], v[16:23], v11
    ds_read_b128 v[190:193], v10 offset:45056
    v_exp_f32 v30, v30
    v_exp_f32 v31, v31
    v_exp_f32 v32, v32
    v_mfma_f32_32x32x4_2b_bf16 v[48:79], v[180:181], v[164:165], v[48:79]
    ds_read_b64 v[180:181], v9 offset:52736
    v_exp_f32 v33, v33
    buffer_load_dwordx4 v[234:237], v242, s[28:31], s66 offen offset:512 sc1
    v_exp_f32 v34, v34
    v_exp_f32 v35, v35
    v_exp_f32 v36, v36
    v_exp_f32 v37, v37
    v_exp_f32 v38, v38
    buffer_load_dwordx2 v[238:239], v243, s[28:31], s66 offen offset:1024 sc1
    v_exp_f32 v39, v39
    v_exp_f32 v40, v40
    v_exp_f32 v41, v41
    v_exp_f32 v42, v42
    v_exp_f32 v43, v43
    s_add_u32 s50, s67, 0
    buffer_load_dwordx2 v[198:199], v244, s[28:31], s50 offen sc1
    v_smfmac_f32_32x32x32_bf16 v[128:143], v[186:189], v[24:31], v11
    ds_read_b128 v[194:197], v10 offset:45824
    v_exp_f32 v44, v44
    v_exp_f32 v45, v45
    v_exp_f32 v46, v46
    v_exp_f32 v47, v47
    s_waitcnt lgkmcnt(3)
    v_mfma_f32_32x32x16_bf16 v[16:31], v[172:175], v[160:163], 0
    v_exp_f32 v48, v48
    v_exp_f32 v49, v49
    s_add_u32 s50, s67, 6144
    buffer_load_dwordx2 v[200:201], v244, s[28:31], s50 offen sc1
    v_exp_f32 v50, v50
    v_smfmac_f32_32x32x32_bf16 v[96:111], v[182:185], v[32:39], v11
    v_exp_f32 v51, v51
    v_exp_f32 v52, v52
    v_exp_f32 v53, v53
    v_smfmac_f32_32x32x32_bf16 v[96:111], v[186:189], v[40:47], v11
    v_exp_f32 v54, v54
    s_add_u32 s50, s67, 12288
    buffer_load_dwordx2 v[202:203], v244, s[28:31], s50 offen sc1
    v_exp_f32 v55, v55
    v_exp_f32 v56, v56
    v_exp_f32 v57, v57
    v_mfma_f32_32x32x16_bf16 v[32:47], v[172:175], v[166:169], 0
    ds_read_b128 v[172:175], v8 offset:56320
    v_exp_f32 v58, v58
    v_exp_f32 v59, v59
    s_add_u32 s50, s67, 18432
    buffer_load_dwordx2 v[204:205], v244, s[28:31], s50 offen sc1
    v_exp_f32 v60, v60
    v_exp_f32 v61, v61
    s_waitcnt lgkmcnt(1)
    v_smfmac_f32_32x32x32_bf16 v[128:143], v[190:193], v[48:55], v11
    ds_read_b128 v[182:185], v10 offset:50688
    v_exp_f32 v62, v62
    v_exp_f32 v63, v63
    v_exp_f32 v64, v64
    v_mfma_f32_32x32x4_2b_bf16 v[16:47], v[180:181], v[164:165], v[16:47]
    ds_read_b64 v[180:181], v9 offset:58368
    v_exp_f32 v65, v65
    s_add_u32 s50, s67, 24576
    buffer_load_dwordx2 v[206:207], v244, s[28:31], s50 offen sc1
    v_exp_f32 v66, v66
    v_exp_f32 v67, v67
    v_exp_f32 v68, v68
    v_exp_f32 v69, v69
    v_exp_f32 v70, v70
    s_add_u32 s50, s67, 30720
    buffer_load_dwordx2 v[208:209], v244, s[28:31], s50 offen sc1
    v_exp_f32 v71, v71
    v_exp_f32 v72, v72
    v_exp_f32 v73, v73
    v_exp_f32 v74, v74
    v_exp_f32 v75, v75
    s_add_u32 s50, s67, 36864
    buffer_load_dwordx2 v[210:211], v244, s[28:31], s50 offen sc1
    v_smfmac_f32_32x32x32_bf16 v[128:143], v[194:197], v[56:63], v11
    ds_read_b128 v[186:189], v10 offset:51456
    v_exp_f32 v76, v76
    v_exp_f32 v77, v77
    v_exp_f32 v78, v78
    v_exp_f32 v79, v79
    s_waitcnt lgkmcnt(3)
    v_mfma_f32_32x32x16_bf16 v[48:63], v[172:175], v[160:163], 0
    v_exp_f32 v16, v16
    v_exp_f32 v17, v17
    s_add_u32 s50, s67, 43008
    buffer_load_dwordx2 v[212:213], v244, s[28:31], s50 offen sc1
    v_exp_f32 v18, v18
    v_smfmac_f32_32x32x32_bf16 v[96:111], v[190:193], v[64:71], v11
    v_exp_f32 v19, v19
    v_exp_f32 v20, v20
    v_exp_f32 v21, v21
    v_smfmac_f32_32x32x32_bf16 v[96:111], v[194:197], v[72:79], v11
    v_exp_f32 v22, v22
    s_add_u32 s50, s67, 49152
    buffer_load_dwordx2 v[214:215], v244, s[28:31], s50 offen sc1
    v_exp_f32 v23, v23
    v_exp_f32 v24, v24
    v_exp_f32 v25, v25
    v_mfma_f32_32x32x16_bf16 v[64:79], v[172:175], v[166:169], 0
    ds_read_b128 v[172:175], v8 offset:61952
    v_exp_f32 v26, v26
    v_exp_f32 v27, v27
    s_add_u32 s50, s67, 55296
    buffer_load_dwordx2 v[216:217], v244, s[28:31], s50 offen sc1
    v_exp_f32 v28, v28
    v_exp_f32 v29, v29
    s_waitcnt lgkmcnt(1)
    v_smfmac_f32_32x32x32_bf16 v[128:143], v[182:185], v[16:23], v11
    ds_read_b128 v[190:193], v10 offset:56320
    v_exp_f32 v30, v30
    v_exp_f32 v31, v31
    v_exp_f32 v32, v32
    v_mfma_f32_32x32x4_2b_bf16 v[48:79], v[180:181], v[164:165], v[48:79]
    ds_read_b64 v[180:181], v9 offset:64000
    v_exp_f32 v33, v33
    s_add_u32 s50, s67, 61440
    buffer_load_dwordx2 v[218:219], v244, s[28:31], s50 offen sc1
    v_exp_f32 v34, v34
    v_exp_f32 v35, v35
    v_exp_f32 v36, v36
    v_exp_f32 v37, v37
    v_exp_f32 v38, v38
    s_add_u32 s50, s67, 67584
    buffer_load_dwordx2 v[220:221], v244, s[28:31], s50 offen sc1
    v_exp_f32 v39, v39
    v_exp_f32 v40, v40
    v_exp_f32 v41, v41
    v_exp_f32 v42, v42
    v_exp_f32 v43, v43
    s_add_u32 s50, s67, 73728
    buffer_load_dwordx2 v[222:223], v244, s[28:31], s50 offen sc1
    v_smfmac_f32_32x32x32_bf16 v[128:143], v[186:189], v[24:31], v11
    ds_read_b128 v[194:197], v10 offset:57088
    v_exp_f32 v44, v44
    v_exp_f32 v45, v45
    v_exp_f32 v46, v46
    v_exp_f32 v47, v47
    s_waitcnt lgkmcnt(3)
    v_mfma_f32_32x32x16_bf16 v[16:31], v[172:175], v[160:163], 0
    v_exp_f32 v48, v48
    v_exp_f32 v49, v49
    s_add_u32 s50, s67, 79872
    buffer_load_dwordx2 v[224:225], v244, s[28:31], s50 offen sc1
    v_exp_f32 v50, v50
    v_smfmac_f32_32x32x32_bf16 v[96:111], v[182:185], v[32:39], v11
    v_exp_f32 v51, v51
    v_exp_f32 v52, v52
    v_exp_f32 v53, v53
    v_smfmac_f32_32x32x32_bf16 v[96:111], v[186:189], v[40:47], v11
    v_exp_f32 v54, v54
    s_add_u32 s50, s67, 86016
    buffer_load_dwordx2 v[226:227], v244, s[28:31], s50 offen sc1
    v_exp_f32 v55, v55
    v_exp_f32 v56, v56
    v_exp_f32 v57, v57
    v_mfma_f32_32x32x16_bf16 v[32:47], v[172:175], v[166:169], 0
    v_add_u32 v8, 61952, v8
    ds_read_b128 v[172:175], v8 offset:5632
    v_exp_f32 v58, v58
    v_exp_f32 v59, v59
    s_add_u32 s50, s67, 92160
    buffer_load_dwordx2 v[228:229], v244, s[28:31], s50 offen sc1
    v_exp_f32 v60, v60
    v_exp_f32 v61, v61
    s_waitcnt lgkmcnt(1)
    v_smfmac_f32_32x32x32_bf16 v[128:143], v[190:193], v[48:55], v11
    ds_read_b128 v[182:185], v10 offset:61952
    v_exp_f32 v62, v62
    v_exp_f32 v63, v63
    v_exp_f32 v64, v64
    v_mfma_f32_32x32x4_2b_bf16 v[16:47], v[180:181], v[164:165], v[16:47]
    v_add_u32 v9, 61952, v9
    ds_read_b64 v[180:181], v9 offset:7680
    v_exp_f32 v65, v65
    v_exp_f32 v66, v66
    v_exp_f32 v67, v67
    v_exp_f32 v68, v68
    v_exp_f32 v69, v69
    v_exp_f32 v70, v70
    v_exp_f32 v71, v71
    v_exp_f32 v72, v72
    v_exp_f32 v73, v73
    v_exp_f32 v74, v74
    v_exp_f32 v75, v75
    v_smfmac_f32_32x32x32_bf16 v[128:143], v[194:197], v[56:63], v11
    ds_read_b128 v[186:189], v10 offset:62720
    v_exp_f32 v76, v76
    v_exp_f32 v77, v77
    v_exp_f32 v78, v78
    v_exp_f32 v79, v79
    s_setprio 1
    s_waitcnt lgkmcnt(3)
    v_mfma_f32_32x32x16_bf16 v[48:63], v[172:175], v[160:163], 0
    v_exp_f32 v16, v16
    v_exp_f32 v17, v17
    v_exp_f32 v18, v18
    v_smfmac_f32_32x32x32_bf16 v[96:111], v[190:193], v[64:71], v11
    v_exp_f32 v19, v19
    v_exp_f32 v20, v20
    v_exp_f32 v21, v21
    v_smfmac_f32_32x32x32_bf16 v[96:111], v[194:197], v[72:79], v11
    v_exp_f32 v22, v22
    v_exp_f32 v23, v23
    v_exp_f32 v24, v24
    v_exp_f32 v25, v25
    v_mfma_f32_32x32x16_bf16 v[64:79], v[172:175], v[166:169], 0
    ds_read_b128 v[172:175], v8 offset:11264
    v_exp_f32 v26, v26
    v_exp_f32 v27, v27
    v_exp_f32 v28, v28
    v_exp_f32 v29, v29
    s_waitcnt lgkmcnt(1)
    v_smfmac_f32_32x32x32_bf16 v[128:143], v[182:185], v[16:23], v11
    v_add_u32 v10, 61952, v10
    ds_read_b128 v[190:193], v10 offset:5632
    v_exp_f32 v30, v30
    v_exp_f32 v31, v31
    v_exp_f32 v32, v32
    v_mfma_f32_32x32x4_2b_bf16 v[48:79], v[180:181], v[164:165], v[48:79]
    ds_read_b64 v[180:181], v9 offset:13312
    v_exp_f32 v33, v33
    v_exp_f32 v34, v34
    v_exp_f32 v35, v35
    v_exp_f32 v36, v36
    v_exp_f32 v37, v37
    v_exp_f32 v38, v38
    v_exp_f32 v39, v39
    v_exp_f32 v40, v40
    v_exp_f32 v41, v41
    v_exp_f32 v42, v42
    v_exp_f32 v43, v43
    v_smfmac_f32_32x32x32_bf16 v[128:143], v[186:189], v[24:31], v11
    ds_read_b128 v[194:197], v10 offset:6400
    v_exp_f32 v44, v44
    v_exp_f32 v45, v45
    v_exp_f32 v46, v46
    v_exp_f32 v47, v47
    s_waitcnt lgkmcnt(3)
    v_mfma_f32_32x32x16_bf16 v[16:31], v[172:175], v[160:163], 0
    v_exp_f32 v48, v48
    v_exp_f32 v49, v49
    v_exp_f32 v50, v50
    v_smfmac_f32_32x32x32_bf16 v[96:111], v[182:185], v[32:39], v11
    v_exp_f32 v51, v51
    v_exp_f32 v52, v52
    v_exp_f32 v53, v53
    v_smfmac_f32_32x32x32_bf16 v[96:111], v[186:189], v[40:47], v11
    v_exp_f32 v54, v54
    v_exp_f32 v55, v55
    v_exp_f32 v56, v56
    v_exp_f32 v57, v57
    v_mfma_f32_32x32x16_bf16 v[32:47], v[172:175], v[166:169], 0
    ds_read_b128 v[172:175], v8 offset:16896
    v_exp_f32 v58, v58
    v_exp_f32 v59, v59
    v_exp_f32 v60, v60
    v_exp_f32 v61, v61
    s_waitcnt lgkmcnt(1)
    v_smfmac_f32_32x32x32_bf16 v[128:143], v[190:193], v[48:55], v11
    ds_read_b128 v[182:185], v10 offset:11264
    v_exp_f32 v62, v62
    v_exp_f32 v63, v63
    v_exp_f32 v64, v64
    v_mfma_f32_32x32x4_2b_bf16 v[16:47], v[180:181], v[164:165], v[16:47]
    ds_read_b64 v[180:181], v9 offset:18944
    v_exp_f32 v65, v65
    v_exp_f32 v66, v66
    v_exp_f32 v67, v67
    v_exp_f32 v68, v68
    v_exp_f32 v69, v69
    v_exp_f32 v70, v70
    v_exp_f32 v71, v71
    s_waitcnt vmcnt(0)
    v_pk_add_f32 v[198:199], v[198:199], v[214:215]
    v_pk_add_f32 v[200:201], v[200:201], v[216:217]
    v_pk_add_f32 v[202:203], v[202:203], v[218:219]
    v_pk_add_f32 v[204:205], v[204:205], v[220:221]
    v_pk_add_f32 v[206:207], v[206:207], v[222:223]
    v_pk_add_f32 v[208:209], v[208:209], v[224:225]
    v_pk_add_f32 v[210:211], v[210:211], v[226:227]
    v_pk_add_f32 v[212:213], v[212:213], v[228:229]
    v_pk_add_f32 v[198:199], v[198:199], v[206:207]
    v_pk_add_f32 v[200:201], v[200:201], v[208:209]
    v_pk_add_f32 v[202:203], v[202:203], v[210:211]
    v_pk_add_f32 v[204:205], v[204:205], v[212:213]
    v_pk_add_f32 v[198:199], v[198:199], v[202:203]
    v_pk_add_f32 v[200:201], v[200:201], v[204:205]
    v_pk_add_f32 v[198:199], v[198:199], v[200:201]
    v_lshrrev_b32 v202, 1, v244
    v_cvt_pk_bf16_f32 v198, v198, v199
    v_add_u32 v202, 159744, v202
    ds_write_b32 v202, v198
    v_exp_f32 v72, v72
    v_exp_f32 v73, v73
    s_setprio 0
    v_exp_f32 v74, v74
    v_exp_f32 v75, v75
    v_smfmac_f32_32x32x32_bf16 v[128:143], v[194:197], v[56:63], v11
    ds_read_b128 v[186:189], v10 offset:12032
    v_exp_f32 v76, v76
    v_exp_f32 v77, v77
    v_exp_f32 v78, v78
    v_exp_f32 v79, v79
    s_add_u32 s58, s70, 102400
    s_lshl_b32 s50, s36, 10
    s_add_u32 s51, s58, s50
    s_add_u32 m0, s50, 45056
    s_lshr_b32 s54, s36, 1
    s_and_b32 s55, s50, 1024
    s_mul_i32 s56, s54, 51200
    s_mul_i32 s54, s54, 6144
    s_add_u32 s56, s56, s55
    s_add_u32 s54, s54, s55
    s_add_u32 s56, s56, s70
    s_add_u32 s56, s56, 45056
    s_add_u32 s54, s54, 147456
    s_cmp_ge_u32 s3, 4
    s_cselect_b32 s51, s56, s51
    s_cselect_b32 m0, s54, m0
    s_cselect_b32 s56, 51200, 0
    s_cselect_b32 s54, 6144, 0
    s_add_u32 s56, s56, 47104
    s_add_u32 s56, s56, s50
    s_add_u32 s54, s54, s50
    s_add_u32 s56, s56, s70
    v_lshlrev_b32 v93, 6, v5
    v_lshl_add_u32 v93, v3, 2, v93
    s_waitcnt lgkmcnt(0)
    s_barrier
    buffer_load_dword v93, v93, s[28:31], s69 offen sc1
    buffer_load_dwordx4 v2, s[28:31], s51 offen sc1 lds
    s_add_u32 m0, s54, 149504
    s_add_u32 s58, s58, 4096
    buffer_load_dwordx4 v2, s[28:31], s56 offen sc1 lds
    s_add_u32 s58, s58, s74
    s_add_u32 m0, s74, 49152
    s_setprio 3
    v_mfma_f32_32x32x16_bf16 v[48:63], v[172:175], v[160:163], 0
    v_exp_f32 v16, v16
    v_exp_f32 v17, v17
    v_lshl_add_u32 v228, v6, 3, v250
    ds_read_b128 v[218:221], v228 offset:0
    ds_read_b128 v[222:225], v228 offset:512
    ds_read_b64 v[226:227], v250 offset:1024
    v_exp_f32 v18, v18
    v_smfmac_f32_32x32x32_bf16 v[96:111], v[190:193], v[64:71], v11
    v_exp_f32 v19, v19
    v_exp_f32 v20, v20
    v_exp_f32 v21, v21
    v_smfmac_f32_32x32x32_bf16 v[96:111], v[194:197], v[72:79], v11
    v_exp_f32 v22, v22
    v_exp_f32 v23, v23
    buffer_load_dwordx4 v2, s[28:31], s58 offen sc1 lds
    s_add_u32 m0, m0, 8192
    s_add_u32 s58, s58, 8192
    v_exp_f32 v24, v24
    v_exp_f32 v25, v25
    v_mfma_f32_32x32x16_bf16 v[64:79], v[172:175], v[166:169], 0
    v_add_u32 v8, 4294849024, v8
    ds_read_b128 v[172:175], v8 offset:5632
    v_exp_f32 v26, v26
    v_exp_f32 v27, v27
    v_exp_f32 v28, v28
    v_exp_f32 v29, v29
    v_smfmac_f32_32x32x32_bf16 v[128:143], v[182:185], v[16:23], v11
    v_add_u32 v10, 4294843392, v10
    ds_read_b128 v[190:193], v10 offset:5632
    v_exp_f32 v30, v30
    v_exp_f32 v31, v31
    v_exp_f32 v32, v32
    v_mfma_f32_32x32x4_2b_bf16 v[48:79], v[180:181], v[164:165], v[48:79]
    v_add_u32 v9, 4294849024, v9
    ds_read_b64 v[180:181], v9 offset:7680
    v_exp_f32 v33, v33
    v_exp_f32 v34, v34
    v_exp_f32 v35, v35
    v_exp_f32 v36, v36
    v_exp_f32 v37, v37
    v_exp_f32 v38, v38
    v_exp_f32 v39, v39
    s_waitcnt lgkmcnt(3)
    v_mfma_f32_32x32x16_bf16 v[198:213], v[218:221], v[230:233], 0
    v_exp_f32 v40, v40
    v_exp_f32 v41, v41
    v_mfma_f32_32x32x16_bf16 v[198:213], v[222:225], v[234:237], v[198:213]
    buffer_load_dwordx4 v2, s[28:31], s58 offen sc1 lds
    s_add_u32 m0, m0, 8192
    s_add_u32 s58, s58, 8192
    v_exp_f32 v42, v42
    v_exp_f32 v43, v43
    v_smfmac_f32_32x32x32_bf16 v[128:143], v[186:189], v[24:31], v11
    ds_read_b128 v[194:197], v10 offset:6400
    v_exp_f32 v44, v44
    v_exp_f32 v45, v45
    v_mfma_f32_32x32x8_bf16 v[198:213], v[226:227], v[238:239], v[198:213]
    buffer_load_dwordx4 v2, s[28:31], s58 offen sc1 lds
    s_add_u32 m0, m0, 8192
    s_add_u32 s58, s58, 8192
    v_exp_f32 v46, v46
    v_exp_f32 v47, v47
    s_waitcnt lgkmcnt(3)
    v_mfma_f32_32x32x16_bf16 v[16:31], v[172:175], v[160:163], 0
    v_exp_f32 v48, v48
    v_exp_f32 v49, v49
    v_exp_f32 v50, v50
    v_smfmac_f32_32x32x32_bf16 v[96:111], v[182:185], v[32:39], v11
    v_exp_f32 v51, v51
    v_exp_f32 v52, v52
    v_exp_f32 v53, v53
    v_smfmac_f32_32x32x32_bf16 v[96:111], v[186:189], v[40:47], v11
    v_exp_f32 v54, v54
    v_exp_f32 v55, v55
    buffer_load_dwordx4 v2, s[28:31], s58 offen sc1 lds
    s_add_u32 m0, m0, 8192
    s_add_u32 s58, s58, 8192
    v_exp_f32 v56, v56
    v_exp_f32 v57, v57
    s_add_u32 s54, s64, 20480
    s_add_u32 s55, s65, 20480
    v_add_f32 v210, 897988541, v210
    s_waitcnt vmcnt(6)
    v_rcp_f32 v220, v210
    v_sub_f32 v221, 1.0, v93
    v_mul_f32 v220, v220, v221
    v_pk_mul_f32 v[198:199], v[198:199], v[220:221] op_sel_hi:[1,0]
    v_pk_mul_f32 v[200:201], v[200:201], v[220:221] op_sel_hi:[1,0]
    v_pk_mul_f32 v[202:203], v[202:203], v[220:221] op_sel_hi:[1,0]
    v_pk_mul_f32 v[204:205], v[204:205], v[220:221] op_sel_hi:[1,0]
    v_pk_mul_f32 v[206:207], v[206:207], v[220:221] op_sel_hi:[1,0]
    v_pk_mul_f32 v[208:209], v[208:209], v[220:221] op_sel_hi:[1,0]
    v_cvt_pk_bf16_f32 v214, v198, v199
    v_cvt_pk_bf16_f32 v215, v200, v201
    v_cvt_pk_bf16_f32 v216, v202, v203
    v_cvt_pk_bf16_f32 v217, v204, v205
    v_cvt_pk_bf16_f32 v218, v206, v207
    v_cvt_pk_bf16_f32 v219, v208, v209
    buffer_store_dwordx4 v[214:217], v251, s[28:31], s54 offen sc1
    buffer_store_dwordx2 v[218:219], v252, s[28:31], s55 offen sc1
    v_mfma_f32_32x32x16_bf16 v[32:47], v[172:175], v[166:169], 0
    ds_read_b128 v[172:175], v8 offset:11264
    v_exp_f32 v58, v58
    v_exp_f32 v59, v59
    v_exp_f32 v60, v60
    v_exp_f32 v61, v61
    s_waitcnt lgkmcnt(1)
    v_smfmac_f32_32x32x32_bf16 v[128:143], v[190:193], v[48:55], v11
    ds_read_b128 v[182:185], v10 offset:11264
    v_exp_f32 v62, v62
    v_exp_f32 v63, v63
    v_exp_f32 v64, v64
    v_mfma_f32_32x32x4_2b_bf16 v[16:47], v[180:181], v[164:165], v[16:47]
    ds_read_b64 v[180:181], v9 offset:13312
    v_exp_f32 v65, v65
    v_exp_f32 v66, v66
    v_exp_f32 v67, v67
    v_exp_f32 v68, v68
    v_exp_f32 v69, v69
    v_exp_f32 v70, v70
    v_exp_f32 v71, v71
    v_exp_f32 v72, v72
    v_exp_f32 v73, v73
    buffer_load_dwordx4 v2, s[28:31], s58 offen sc1 lds
    s_add_u32 m0, m0, 8192
    s_add_u32 s58, s58, 8192
    v_exp_f32 v74, v74
    v_exp_f32 v75, v75
    v_smfmac_f32_32x32x32_bf16 v[128:143], v[194:197], v[56:63], v11
    ds_read_b128 v[186:189], v10 offset:12032
    v_exp_f32 v76, v76
    v_exp_f32 v77, v77
    buffer_load_dwordx4 v2, s[28:31], s58 offen sc1 lds
    s_add_u32 m0, m0, 8192
    s_add_u32 s58, s58, 8192
    v_exp_f32 v78, v78
    v_exp_f32 v79, v79
    s_waitcnt lgkmcnt(3)
    v_mfma_f32_32x32x16_bf16 v[48:63], v[172:175], v[160:163], 0
    v_exp_f32 v16, v16
    v_exp_f32 v17, v17
    v_exp_f32 v18, v18
    v_smfmac_f32_32x32x32_bf16 v[96:111], v[190:193], v[64:71], v11
    v_exp_f32 v19, v19
    v_exp_f32 v20, v20
    v_exp_f32 v21, v21
    v_smfmac_f32_32x32x32_bf16 v[96:111], v[194:197], v[72:79], v11
    v_exp_f32 v22, v22
    v_exp_f32 v23, v23
    buffer_load_dwordx4 v2, s[28:31], s58 offen sc1 lds
    s_add_u32 m0, m0, 8192
    s_add_u32 s58, s58, 8192
    v_exp_f32 v24, v24
    v_exp_f32 v25, v25
    v_mfma_f32_32x32x16_bf16 v[64:79], v[172:175], v[166:169], 0
    ds_read_b128 v[172:175], v8 offset:16896
    v_exp_f32 v26, v26
    v_exp_f32 v27, v27
    v_exp_f32 v28, v28
    v_exp_f32 v29, v29
    s_waitcnt lgkmcnt(1)
    v_smfmac_f32_32x32x32_bf16 v[128:143], v[182:185], v[16:23], v11
    ds_read_b128 v[190:193], v10 offset:16896
    v_exp_f32 v30, v30
    v_exp_f32 v31, v31
    v_exp_f32 v32, v32
    v_mfma_f32_32x32x4_2b_bf16 v[48:79], v[180:181], v[164:165], v[48:79]
    ds_read_b64 v[180:181], v9 offset:18944
    v_exp_f32 v33, v33
    v_exp_f32 v34, v34
    v_exp_f32 v35, v35
    v_exp_f32 v36, v36
    v_exp_f32 v37, v37
    v_exp_f32 v38, v38
    v_exp_f32 v39, v39
    v_exp_f32 v40, v40
    v_exp_f32 v41, v41
    buffer_load_dwordx4 v2, s[28:31], s58 offen sc1 lds
    s_add_u32 m0, m0, 8192
    s_add_u32 s58, s58, 8192
    v_exp_f32 v42, v42
    v_exp_f32 v43, v43
    v_smfmac_f32_32x32x32_bf16 v[128:143], v[186:189], v[24:31], v11
    ds_read_b128 v[194:197], v10 offset:17664
    v_exp_f32 v44, v44
    v_exp_f32 v45, v45
    buffer_load_dwordx4 v2, s[28:31], s58 offen sc1 lds
    s_add_u32 m0, m0, 8192
    s_add_u32 s58, s58, 8192
    v_exp_f32 v46, v46
    v_exp_f32 v47, v47
    s_waitcnt lgkmcnt(3)
    v_mfma_f32_32x32x16_bf16 v[16:31], v[172:175], v[160:163], 0
    v_exp_f32 v48, v48
    v_exp_f32 v49, v49
    v_exp_f32 v50, v50
    v_smfmac_f32_32x32x32_bf16 v[96:111], v[182:185], v[32:39], v11
    v_exp_f32 v51, v51
    v_exp_f32 v52, v52
    v_exp_f32 v53, v53
    v_smfmac_f32_32x32x32_bf16 v[96:111], v[186:189], v[40:47], v11
    v_exp_f32 v54, v54
    v_exp_f32 v55, v55
    buffer_load_dwordx4 v2, s[28:31], s58 offen sc1 lds
    s_add_u32 m0, m0, 8192
    s_add_u32 s58, s58, 8192
    v_exp_f32 v56, v56
    v_exp_f32 v57, v57
    v_mfma_f32_32x32x16_bf16 v[32:47], v[172:175], v[166:169], 0
    ds_read_b128 v[172:175], v8 offset:22528
    v_exp_f32 v58, v58
    v_exp_f32 v59, v59
    v_exp_f32 v60, v60
    v_exp_f32 v61, v61
    s_waitcnt lgkmcnt(1)
    v_smfmac_f32_32x32x32_bf16 v[128:143], v[190:193], v[48:55], v11
    ds_read_b128 v[182:185], v10 offset:22528
    v_exp_f32 v62, v62
    v_exp_f32 v63, v63
    v_exp_f32 v64, v64
    v_mfma_f32_32x32x4_2b_bf16 v[16:47], v[180:181], v[164:165], v[16:47]
    ds_read_b64 v[180:181], v9 offset:24576
    v_exp_f32 v65, v65
    v_exp_f32 v66, v66
    v_exp_f32 v67, v67
    v_exp_f32 v68, v68
    v_exp_f32 v69, v69
    v_exp_f32 v70, v70
    v_exp_f32 v71, v71
    v_exp_f32 v72, v72
    v_exp_f32 v73, v73
    buffer_load_dwordx4 v2, s[28:31], s58 offen sc1 lds
    s_add_u32 m0, m0, 8192
    s_add_u32 s58, s58, 8192
    v_exp_f32 v74, v74
    v_exp_f32 v75, v75
    v_smfmac_f32_32x32x32_bf16 v[128:143], v[194:197], v[56:63], v11
    ds_read_b128 v[186:189], v10 offset:23296
    v_exp_f32 v76, v76
    v_exp_f32 v77, v77
    buffer_load_dwordx4 v2, s[28:31], s58 offen sc1 lds
    s_add_u32 m0, m0, 8192
    s_add_u32 s58, s58, 8192
    v_exp_f32 v78, v78
    v_exp_f32 v79, v79
    s_setprio 2
    s_waitcnt lgkmcnt(3)
    v_mfma_f32_32x32x16_bf16 v[48:63], v[172:175], v[160:163], 0
    v_exp_f32 v16, v16
    v_exp_f32 v17, v17
    v_exp_f32 v18, v18
    v_smfmac_f32_32x32x32_bf16 v[96:111], v[190:193], v[64:71], v11
    v_exp_f32 v19, v19
    v_exp_f32 v20, v20
    v_exp_f32 v21, v21
    v_smfmac_f32_32x32x32_bf16 v[96:111], v[194:197], v[72:79], v11
    v_exp_f32 v22, v22
    v_exp_f32 v23, v23
    v_exp_f32 v24, v24
    v_exp_f32 v25, v25
    v_mfma_f32_32x32x16_bf16 v[64:79], v[172:175], v[166:169], 0
    ds_read_b128 v[172:175], v8 offset:28160
    v_exp_f32 v26, v26
    v_exp_f32 v27, v27
    v_exp_f32 v28, v28
    v_exp_f32 v29, v29
    s_waitcnt lgkmcnt(1)
    v_smfmac_f32_32x32x32_bf16 v[128:143], v[182:185], v[16:23], v11
    ds_read_b128 v[190:193], v10 offset:28160
    v_exp_f32 v30, v30
    v_exp_f32 v31, v31
    v_exp_f32 v32, v32
    v_mfma_f32_32x32x4_2b_bf16 v[48:79], v[180:181], v[164:165], v[48:79]
    ds_read_b64 v[180:181], v9 offset:30208
    v_exp_f32 v33, v33
    v_exp_f32 v34, v34
    v_exp_f32 v35, v35
    v_exp_f32 v36, v36
    v_exp_f32 v37, v37
    v_exp_f32 v38, v38
    v_exp_f32 v39, v39
    v_exp_f32 v40, v40
    v_exp_f32 v41, v41
    v_exp_f32 v42, v42
    v_exp_f32 v43, v43
    v_smfmac_f32_32x32x32_bf16 v[128:143], v[186:189], v[24:31], v11
    ds_read_b128 v[194:197], v10 offset:28928
    v_exp_f32 v44, v44
    v_exp_f32 v45, v45
    v_exp_f32 v46, v46
    v_exp_f32 v47, v47
    s_add_u32 s52, s68, 20480
    s_waitcnt lgkmcnt(3)
    v_mfma_f32_32x32x16_bf16 v[16:31], v[172:175], v[160:163], 0
    v_exp_f32 v48, v48
    v_exp_f32 v49, v49
    v_exp_f32 v50, v50
    v_smfmac_f32_32x32x32_bf16 v[96:111], v[182:185], v[32:39], v11
    v_exp_f32 v51, v51
    v_exp_f32 v52, v52
    v_exp_f32 v53, v53
    v_smfmac_f32_32x32x32_bf16 v[96:111], v[186:189], v[40:47], v11
    v_exp_f32 v54, v54
    v_exp_f32 v55, v55
    v_exp_f32 v56, v56
    v_exp_f32 v57, v57
    v_mfma_f32_32x32x16_bf16 v[32:47], v[172:175], v[166:169], 0
    ds_read_b128 v[172:175], v8 offset:33792
    v_exp_f32 v58, v58
    v_exp_f32 v59, v59
    v_exp_f32 v60, v60
    v_exp_f32 v61, v61
    s_waitcnt lgkmcnt(1)
    v_smfmac_f32_32x32x32_bf16 v[128:143], v[190:193], v[48:55], v11
    ds_read_b128 v[182:185], v10 offset:33792
    v_exp_f32 v62, v62
    v_exp_f32 v63, v63
    v_exp_f32 v64, v64
    v_mfma_f32_32x32x4_2b_bf16 v[16:47], v[180:181], v[164:165], v[16:47]
    ds_read_b64 v[180:181], v9 offset:35840
    v_exp_f32 v65, v65
    v_exp_f32 v66, v66
    v_exp_f32 v67, v67
    s_waitcnt vmcnt(0)
    v_mov_b32 v12, 163776
    v_mov_b32 v13, 1
    s_mov_b64 exec, 1
    ds_add_u32 v12, v13 offset:48
    s_mov_b64 exec, -1
    v_exp_f32 v68, v68
    v_exp_f32 v69, v69
    v_exp_f32 v70, v70
    v_exp_f32 v71, v71
    s_add_u32 s50, s52, 0
    buffer_load_dwordx4 v[198:201], v2, s[28:31], s50 offen offset:0 sc1
    v_exp_f32 v72, v72
    v_exp_f32 v73, v73
    buffer_load_dwordx4 v[202:205], v2, s[28:31], s50 offen offset:1024 sc1
    v_exp_f32 v74, v74
    v_exp_f32 v75, v75
    buffer_load_dwordx4 v[206:209], v2, s[28:31], s50 offen offset:2048 sc1
    v_smfmac_f32_32x32x32_bf16 v[128:143], v[194:197], v[56:63], v11
    ds_read_b128 v[186:189], v10 offset:34560
    v_exp_f32 v76, v76
    v_exp_f32 v77, v77
    buffer_load_dwordx4 v[210:213], v2, s[28:31], s50 offen offset:3072 sc1
    v_exp_f32 v78, v78
    v_exp_f32 v79, v79
    s_add_u32 s50, s52, 4096
    buffer_load_dwordx4 v[214:217], v2, s[28:31], s50 offen offset:0 sc1
    s_waitcnt lgkmcnt(4)
    v_mfma_f32_32x32x16_bf16 v[48:63], v[172:175], v[160:163], 0
    v_exp_f32 v16, v16
    v_exp_f32 v17, v17
    buffer_load_dwordx4 v[218:221], v2, s[28:31], s50 offen offset:1024 sc1
    v_exp_f32 v18, v18
    v_smfmac_f32_32x32x32_bf16 v[96:111], v[190:193], v[64:71], v11
    v_exp_f32 v19, v19
    buffer_load_dwordx4 v[222:225], v2, s[28:31], s50 offen offset:2048 sc1
    v_exp_f32 v20, v20
    v_exp_f32 v21, v21
    buffer_load_dwordx4 v[226:229], v2, s[28:31], s50 offen offset:3072 sc1
    v_smfmac_f32_32x32x32_bf16 v[96:111], v[194:197], v[72:79], v11
    v_exp_f32 v22, v22
    v_exp_f32 v23, v23
    s_add_u32 s50, s52, 8192
    buffer_load_dwordx2 v[230:231], v253, s[28:31], s50 offen offset:0 sc1
    v_exp_f32 v24, v24
    v_exp_f32 v25, v25
    buffer_load_dwordx2 v[232:233], v253, s[28:31], s50 offen offset:512 sc1
    v_mfma_f32_32x32x16_bf16 v[64:79], v[172:175], v[166:169], 0
    v_exp_f32 v26, v26
    v_exp_f32 v27, v27
    buffer_load_dwordx2 v[234:235], v253, s[28:31], s50 offen offset:1024 sc1
    v_exp_f32 v28, v28
    v_exp_f32 v29, v29
    buffer_load_dwordx2 v[236:237], v253, s[28:31], s50 offen offset:1536 sc1
    s_waitcnt lgkmcnt(0)
    v_smfmac_f32_32x32x32_bf16 v[128:143], v[182:185], v[16:23], v11
    ds_read_b128 v[190:193], v10 offset:39424
    v_exp_f32 v30, v30
    v_exp_f32 v31, v31
    s_setprio 1
    v_exp_f32 v32, v32
    s_nop 0
    v_mfma_f32_32x32x4_2b_bf16 v[48:79], v[180:181], v[164:165], v[48:79]
    v_exp_f32 v33, v33
    v_exp_f32 v34, v34
    v_exp_f32 v35, v35
    v_exp_f32 v36, v36
    v_exp_f32 v37, v37
    v_exp_f32 v38, v38
    v_exp_f32 v39, v39
    v_exp_f32 v40, v40
    v_exp_f32 v41, v41
    v_exp_f32 v42, v42
    v_exp_f32 v43, v43
    v_smfmac_f32_32x32x32_bf16 v[128:143], v[186:189], v[24:31], v11
    ds_read_b128 v[194:197], v10 offset:40192
    v_exp_f32 v44, v44
    v_exp_f32 v45, v45
    v_exp_f32 v46, v46
    v_exp_f32 v47, v47
    s_nop 4
    v_exp_f32 v48, v48
    v_exp_f32 v49, v49
    v_smfmac_f32_32x32x32_bf16 v[96:111], v[182:185], v[32:39], v11
    v_exp_f32 v50, v50
    v_exp_f32 v51, v51
    v_exp_f32 v52, v52
    v_smfmac_f32_32x32x32_bf16 v[96:111], v[186:189], v[40:47], v11
    v_exp_f32 v53, v53
    v_exp_f32 v54, v54
    v_exp_f32 v55, v55
    v_exp_f32 v56, v56
    v_exp_f32 v57, v57
    s_waitcnt lgkmcnt(0)
    v_smfmac_f32_32x32x32_bf16 v[128:143], v[190:193], v[48:55], v11
    v_exp_f32 v58, v58
    v_exp_f32 v59, v59
    ds_read_b32 v14, v12 offset:48
    s_mul_i32 s50, s3, 4096
    s_xor_b32 s51, s3, 4
    s_mul_i32 s54, s51, 4096
    v_add_u32 v82, s50, v2
    v_add_u32 v83, s54, v2
    s_lshl_b32 s50, s3, 2
    s_lshl_b32 s51, s51, 2
    v_add_u32 v80, s50, v12
    v_add_u32 v81, s51, v12
    v_exp_f32 v60, v60
    v_exp_f32 v61, v61
    v_exp_f32 v62, v62
    v_exp_f32 v63, v63
    v_exp_f32 v64, v64
    v_exp_f32 v65, v65
    v_smfmac_f32_32x32x32_bf16 v[128:143], v[194:197], v[56:63], v11
    v_exp_f32 v66, v66
    v_exp_f32 v67, v67
    v_exp_f32 v68, v68
    v_exp_f32 v69, v69
    v_exp_f32 v70, v70
    v_exp_f32 v71, v71
    s_setprio 0
    v_exp_f32 v72, v72
    v_exp_f32 v73, v73
    v_smfmac_f32_32x32x32_bf16 v[96:111], v[190:193], v[64:71], v11
    s_waitcnt lgkmcnt(0)
    v_cmp_ne_u32 vcc, 8, v14
    v_exp_f32 v74, v74
    v_exp_f32 v75, v75
    s_cbranch_vccnz L_xc
L_xcr:
    ds_write_b128 v82, v[128:131] offset:0
    ds_write_b128 v82, v[132:135] offset:1024
    ds_write_b128 v82, v[136:139] offset:2048
    ds_write_b32 v82, v140 offset:3072
    ds_write_b32 v80, v13
    v_exp_f32 v76, v76
    v_exp_f32 v77, v77
    v_exp_f32 v78, v78
    v_exp_f32 v79, v79
    ds_read_b32 v8, v81
    ds_read_b128 v[16:19], v83 offset:0
    ds_read_b128 v[20:23], v83 offset:1024
    ds_read_b128 v[24:27], v83 offset:2048
    ds_read_b32 v28, v83 offset:3072
    v_smfmac_f32_32x32x32_bf16 v[96:111], v[194:197], v[72:79], v11
    s_waitcnt vmcnt(0)
    v_mov_b32 v10, 1593835520
    v_mov_b32 v9, 2071986176
    v_mov_b32 v15, 729808896
    s_lshr_b32 s53, s3, 2
    s_and_b32 s51, s46, 1
    s_xor_b32 s53, s53, s51
    v_max_u32 v92, v198, v199
    v_max3_u32 v92, v200, v201, v92
    v_max3_u32 v92, v202, v203, v92
    v_max3_u32 v92, v204, v205, v92
    s_waitcnt lgkmcnt(4)
    v_cmp_eq_u32 vcc, 0, v8
    s_cbranch_vccnz L_xw
L_xwr:
    s_waitcnt lgkmcnt(0)
    v_add_f32 v108, v108, v28
    v_pk_add_f32 v[96:97], v[96:97], v[16:17]
    v_pk_add_f32 v[98:99], v[98:99], v[18:19]
    v_pk_add_f32 v[100:101], v[100:101], v[20:21]
    v_pk_add_f32 v[102:103], v[102:103], v[22:23]
    v_pk_add_f32 v[104:105], v[104:105], v[24:25]
    v_pk_add_f32 v[106:107], v[106:107], v[26:27]
    v_add_f32 v13, abs(v96), abs(v97)
    v_add_f32 v13, abs(v98), v13
    v_add_f32 v13, abs(v99), v13
    v_add_f32 v13, abs(v100), v13
    v_add_f32 v13, abs(v101), v13
    v_add_f32 v13, abs(v102), v13
    v_add_f32 v13, abs(v103), v13
    v_add_f32 v13, abs(v104), v13
    v_add_f32 v13, abs(v105), v13
    v_add_f32 v13, abs(v106), v13
    v_add_f32 v13, abs(v107), v13
    v_cmp_nlt_f32 s[58:59], v108, v10
    v_cmp_ngt_f32 s[56:57], v108, v15
    v_cmp_nlt_f32 vcc, v13, v9
L_fin:
    v_rcp_f32 v90, v108
    s_nop 0
    v_mul_f32 v90, v90, v93
    v_pk_mul_f32 v[96:97], v[96:97], v[90:91] op_sel_hi:[1,0]
    v_pk_mul_f32 v[98:99], v[98:99], v[90:91] op_sel_hi:[1,0]
    v_pk_mul_f32 v[100:101], v[100:101], v[90:91] op_sel_hi:[1,0]
    v_pk_mul_f32 v[102:103], v[102:103], v[90:91] op_sel_hi:[1,0]
    v_pk_mul_f32 v[104:105], v[104:105], v[90:91] op_sel_hi:[1,0]
    v_pk_mul_f32 v[106:107], v[106:107], v[90:91] op_sel_hi:[1,0]
    v_cvt_pk_bf16_f32 v84, v96, v97
    v_cvt_pk_bf16_f32 v85, v98, v99
    v_cvt_pk_bf16_f32 v86, v100, v101
    v_cvt_pk_bf16_f32 v87, v102, v103
    v_cvt_pk_bf16_f32 v88, v104, v105
    v_cvt_pk_bf16_f32 v89, v106, v107
    s_or_b64 s[58:59], s[58:59], s[56:57]
    s_or_b64 s[58:59], s[58:59], vcc
    s_cbranch_scc1 L_fallback
    buffer_store_dwordx4 v[84:87], v251, s[28:31], s64 offen sc1
    buffer_store_dwordx2 v[88:89], v252, s[28:31], s65 offen sc1
    s_setprio 0
    s_mul_i32 s50, s53, 51200
    s_add_u32 s33, s70, s50
    s_lshl_b32 s51, s36, 10
    s_add_u32 s56, s33, s51
    s_add_u32 s34, s50, s51
    s_mul_i32 s57, s53, 20480
    s_add_u32 m0, s57, s51
    s_add_u32 s50, s50, 45056
    v_add_u32 v8, s50, v2
    v_add_u32 v9, s57, v2
    s_mul_i32 s50, s53, 6144
    s_add_u32 s50, s50, 147456
    v_add_u32 v11, s50, v2
    s_add_u32 s54, s68, 4096
    s_add_u32 s55, s68, 8192
    s_mov_b32 s51, 400000
    ds_read_b128 v[136:139], v8 offset:0
    ds_read_b128 v[140:143], v8 offset:1024
    ds_read_b128 v[144:147], v8 offset:2048
    ds_read_b128 v[148:151], v8 offset:3072
    ds_read_b128 v[152:155], v8 offset:4096
    v_cmp_eq_u32 vcc, 4290772991, v92
    s_cbranch_vccnz L_retryB0
L_goodB0:
    ds_read_b128 v[156:159], v8 offset:5120
    s_waitcnt lgkmcnt(3)
    v_mfma_f32_16x16x32_bf16 v[116:119], v[136:139], v[198:201], 0
    ds_read_b128 v[160:163], v8 offset:6144
    v_mfma_f32_16x16x32_bf16 v[120:123], v[140:143], v[198:201], 0
    ds_read_b128 v[164:167], v8 offset:7168
    v_mfma_f32_16x16x32_bf16 v[124:127], v[144:147], v[198:201], 0
    ds_read_b128 v[168:171], v8 offset:8192
    s_waitcnt lgkmcnt(4)
    v_mfma_f32_16x16x32_bf16 v[128:131], v[148:151], v[198:201], 0
    ds_read_b128 v[172:175], v8 offset:9216
    v_mfma_f32_16x16x32_bf16 v[132:135], v[152:155], v[198:201], 0
    v_max_u32 v92, v206, v207
    ds_read_b128 v[136:139], v8 offset:10240
    s_waitcnt lgkmcnt(3)
    v_mfma_f32_16x16x32_bf16 v[116:119], v[156:159], v[202:205], v[116:119]
    v_max3_u32 v92, v208, v209, v92
    ds_read_b128 v[140:143], v8 offset:11264
    v_mfma_f32_16x16x32_bf16 v[120:123], v[160:163], v[202:205], v[120:123]
    v_max3_u32 v92, v210, v211, v92
    ds_read_b128 v[144:147], v8 offset:12288
    v_mfma_f32_16x16x32_bf16 v[124:127], v[164:167], v[202:205], v[124:127]
    s_barrier
    buffer_load_dwordx4 v2, s[28:31], s56 offen sc1 lds
    s_add_u32 m0, m0, 4096
    s_add_u32 s56, s56, 4096
    v_max3_u32 v92, v212, v213, v92
    ds_read_b128 v[148:151], v8 offset:13312
    s_waitcnt lgkmcnt(4)
    v_mfma_f32_16x16x32_bf16 v[128:131], v[168:171], v[202:205], v[128:131]
    v_cmp_eq_u32 vcc, 4290772991, v92
    s_cbranch_vccnz L_retryB1
L_goodB1:
    ds_read_b128 v[152:155], v8 offset:14336
    v_mfma_f32_16x16x32_bf16 v[132:135], v[172:175], v[202:205], v[132:135]
    ds_read_b128 v[156:159], v8 offset:15360
    s_waitcnt lgkmcnt(3)
    v_mfma_f32_16x16x32_bf16 v[116:119], v[136:139], v[206:209], v[116:119]
    buffer_load_dwordx4 v2, s[28:31], s56 offen sc1 lds
    s_add_u32 m0, m0, 4096
    s_add_u32 s56, s56, 4096
    ds_read_b128 v[160:163], v8 offset:16384
    v_mfma_f32_16x16x32_bf16 v[120:123], v[140:143], v[206:209], v[120:123]
    ds_read_b128 v[164:167], v8 offset:17408
    v_mfma_f32_16x16x32_bf16 v[124:127], v[144:147], v[206:209], v[124:127]
    ds_read_b128 v[168:171], v8 offset:18432
    s_waitcnt lgkmcnt(4)
    v_mfma_f32_16x16x32_bf16 v[128:131], v[148:151], v[206:209], v[128:131]
    buffer_load_dwordx4 v2, s[28:31], s56 offen sc1 lds
    s_add_u32 m0, m0, 4096
    s_add_u32 s56, s56, 4096
    ds_read_b128 v[172:175], v8 offset:19456
    v_mfma_f32_16x16x32_bf16 v[132:135], v[152:155], v[206:209], v[132:135]
    v_max_u32 v92, v214, v215
    ds_read_b128 v[136:139], v8 offset:20480
    s_waitcnt lgkmcnt(3)
    v_mfma_f32_16x16x32_bf16 v[116:119], v[156:159], v[210:213], v[116:119]
    v_max3_u32 v92, v216, v217, v92
    ds_read_b128 v[140:143], v8 offset:21504
    v_mfma_f32_16x16x32_bf16 v[120:123], v[160:163], v[210:213], v[120:123]
    buffer_load_dwordx4 v2, s[28:31], s56 offen sc1 lds
    s_add_u32 m0, m0, 4096
    s_add_u32 s56, s56, 4096
    v_max3_u32 v92, v218, v219, v92
    ds_read_b128 v[144:147], v8 offset:22528
    v_mfma_f32_16x16x32_bf16 v[124:127], v[164:167], v[210:213], v[124:127]
    v_max3_u32 v92, v220, v221, v92
    ds_read_b128 v[148:151], v8 offset:23552
    s_waitcnt lgkmcnt(4)
    v_mfma_f32_16x16x32_bf16 v[128:131], v[168:171], v[210:213], v[128:131]
    v_cmp_eq_u32 vcc, 4290772991, v92
    s_cbranch_vccnz L_retryB2
L_goodB2:
    ds_read_b128 v[152:155], v8 offset:24576
    v_mfma_f32_16x16x32_bf16 v[132:135], v[172:175], v[210:213], v[132:135]
    buffer_load_dwordx4 v2, s[28:31], s56 offen sc1 lds
    s_add_u32 m0, m0, 4096
    s_add_u32 s56, s56, 4096
    s_mov_b32 s60, s20
    s_mov_b32 s61, s21
    s_mov_b32 s62, 2621440
    s_mov_b32 s63, 0x20000
    s_mul_i32 s57, s46, 160
    s_and_b32 s50, s46, 1
    s_lshl_b32 s50, s50, 5
    s_add_u32 s58, s57, 128
    s_add_u32 s57, s57, s50
    s_lshl_b32 s50, s50, 2
    s_sub_u32 s58, s58, s50
    v_lshl_add_u32 v14, v4, 3, v254
    s_mul_i32 s50, s36, 5120
    s_add_u32 s50, s50, 70656
    v_add_u32 v10, s50, v2
    ds_read_b128 v[156:159], v8 offset:25600
    s_waitcnt lgkmcnt(3)
    v_mfma_f32_16x16x32_bf16 v[116:119], v[136:139], v[214:217], v[116:119]
    ds_read_b128 v[160:163], v8 offset:26624
    v_mfma_f32_16x16x32_bf16 v[120:123], v[140:143], v[214:217], v[120:123]
    ds_read_b128 v[164:167], v8 offset:27648
    v_mfma_f32_16x16x32_bf16 v[124:127], v[144:147], v[214:217], v[124:127]
    buffer_load_dwordx4 v[16:19], v2, s[28:31], s68 offen offset:0 sc1
    ds_read_b128 v[168:171], v8 offset:28672
    s_waitcnt lgkmcnt(4)
    v_mfma_f32_16x16x32_bf16 v[128:131], v[148:151], v[214:217], v[128:131]
    ds_read_b128 v[172:175], v8 offset:29696
    v_mfma_f32_16x16x32_bf16 v[132:135], v[152:155], v[214:217], v[132:135]
    s_add_u32 m0, s34, 45056
    s_barrier
    buffer_load_dwordx4 v2, s[28:31], s56 offen sc1 lds
    s_add_u32 m0, m0, 4096
    s_add_u32 s56, s56, 4096
    v_max_u32 v92, v222, v223
    ds_read_b128 v[136:139], v8 offset:30720
    s_waitcnt lgkmcnt(3)
    v_mfma_f32_16x16x32_bf16 v[116:119], v[156:159], v[218:221], v[116:119]
    v_max3_u32 v92, v224, v225, v92
    ds_read_b128 v[140:143], v8 offset:31744
    v_mfma_f32_16x16x32_bf16 v[120:123], v[160:163], v[218:221], v[120:123]
    v_max3_u32 v92, v226, v227, v92
    ds_read_b128 v[144:147], v8 offset:32768
    v_mfma_f32_16x16x32_bf16 v[124:127], v[164:167], v[218:221], v[124:127]
    buffer_load_dwordx4 v2, s[28:31], s56 offen sc1 lds
    s_add_u32 m0, m0, 4096
    s_add_u32 s56, s56, 4096
    v_max3_u32 v92, v228, v229, v92
    ds_read_b128 v[148:151], v8 offset:33792
    s_waitcnt lgkmcnt(4)
    v_mfma_f32_16x16x32_bf16 v[128:131], v[168:171], v[218:221], v[128:131]
    v_cmp_eq_u32 vcc, 4290772991, v92
    s_cbranch_vccnz L_retryB3
L_goodB3:
    ds_read_b128 v[152:155], v8 offset:34816
    v_mfma_f32_16x16x32_bf16 v[132:135], v[172:175], v[218:221], v[132:135]
    ds_read_b128 v[156:159], v8 offset:35840
    s_waitcnt lgkmcnt(3)
    v_mfma_f32_16x16x32_bf16 v[116:119], v[136:139], v[222:225], v[116:119]
    ds_read_b128 v[160:163], v8 offset:36864
    v_mfma_f32_16x16x32_bf16 v[120:123], v[140:143], v[222:225], v[120:123]
    buffer_load_dwordx4 v2, s[28:31], s56 offen sc1 lds
    s_add_u32 m0, m0, 4096
    s_add_u32 s56, s56, 4096
    ds_read_b128 v[164:167], v8 offset:37888
    v_mfma_f32_16x16x32_bf16 v[124:127], v[144:147], v[222:225], v[124:127]
    ds_read_b128 v[168:171], v8 offset:38912
    s_waitcnt lgkmcnt(4)
    v_mfma_f32_16x16x32_bf16 v[128:131], v[148:151], v[222:225], v[128:131]
    ds_read_b128 v[172:175], v8 offset:39936
    v_mfma_f32_16x16x32_bf16 v[132:135], v[152:155], v[222:225], v[132:135]
    buffer_load_dwordx4 v2, s[28:31], s56 offen sc1 lds
    s_add_u32 m0, m0, 4096
    s_add_u32 s56, s56, 4096
    v_max_u32 v92, v230, v231
    ds_read_b128 v[136:139], v8 offset:40960
    s_waitcnt lgkmcnt(3)
    v_mfma_f32_16x16x32_bf16 v[116:119], v[156:159], v[226:229], v[116:119]
    v_max3_u32 v92, v232, v233, v92
    ds_read_b128 v[140:143], v8 offset:41984
    v_mfma_f32_16x16x32_bf16 v[120:123], v[160:163], v[226:229], v[120:123]
    v_max3_u32 v92, v234, v235, v92
    ds_read_b128 v[144:147], v8 offset:43008
    v_mfma_f32_16x16x32_bf16 v[124:127], v[164:167], v[226:229], v[124:127]
    buffer_load_dwordx4 v[20:23], v2, s[28:31], s68 offen offset:1024 sc1
    v_max3_u32 v92, v236, v237, v92
    ds_read_b128 v[148:151], v8 offset:44032
    s_waitcnt lgkmcnt(4)
    v_mfma_f32_16x16x32_bf16 v[128:131], v[168:171], v[226:229], v[128:131]
    buffer_load_dwordx4 v2, s[28:31], s56 offen sc1 lds
    s_add_u32 m0, m0, 4096
    s_add_u32 s56, s56, 4096
    v_cmp_eq_u32 vcc, 4290772991, v92
    s_cbranch_vccnz L_retryB4
L_goodB4:
    ds_read_b128 v[152:155], v8 offset:45056
    v_mfma_f32_16x16x32_bf16 v[132:135], v[172:175], v[226:229], v[132:135]
    ds_read_b128 v[156:159], v8 offset:46080
    s_waitcnt lgkmcnt(3)
    v_mfma_f32_16x16x32_bf16 v[116:119], v[136:139], v[230:233], v[116:119]
    ds_read_b128 v[160:163], v8 offset:47104
    v_mfma_f32_16x16x32_bf16 v[120:123], v[140:143], v[230:233], v[120:123]
    buffer_load_dwordx4 v2, s[28:31], s56 offen sc1 lds
    s_add_u32 m0, m0, 4096
    s_add_u32 s56, s56, 4096
    ds_read_b128 v[164:167], v8 offset:48128
    v_mfma_f32_16x16x32_bf16 v[124:127], v[144:147], v[230:233], v[124:127]
    ds_read_b128 v[168:171], v8 offset:49152
    s_waitcnt lgkmcnt(4)
    v_mfma_f32_16x16x32_bf16 v[128:131], v[148:151], v[230:233], v[128:131]
    ds_read_b128 v[172:175], v8 offset:50176
    v_mfma_f32_16x16x32_bf16 v[132:135], v[152:155], v[230:233], v[132:135]
    s_waitcnt vmcnt(8)
    s_barrier
    ds_read_b128 v[136:139], v9 offset:0
    s_waitcnt lgkmcnt(3)
    v_mfma_f32_16x16x32_bf16 v[116:119], v[156:159], v[234:237], v[116:119]
    buffer_load_dwordx4 v[24:27], v2, s[28:31], s68 offen offset:2048 sc1
    ds_read_b128 v[140:143], v9 offset:1024
    v_mfma_f32_16x16x32_bf16 v[120:123], v[160:163], v[234:237], v[120:123]
    ds_read_b128 v[144:147], v9 offset:2048
    v_mfma_f32_16x16x32_bf16 v[124:127], v[164:167], v[234:237], v[124:127]
    s_waitcnt vmcnt(8)
    v_max_u32 v92, v16, v17
    v_max3_u32 v92, v18, v19, v92
    ds_read_b128 v[148:151], v9 offset:3072
    s_waitcnt lgkmcnt(4)
    v_mfma_f32_16x16x32_bf16 v[128:131], v[168:171], v[234:237], v[128:131]
    buffer_load_dwordx4 v[28:31], v2, s[28:31], s68 offen offset:3072 sc1
    v_cmp_eq_u32 vcc, 4290772991, v92
    s_cbranch_vccnz L_retryA0
L_goodA0:
    ds_read_b128 v[152:155], v9 offset:4096
    v_mfma_f32_16x16x32_bf16 v[132:135], v[172:175], v[234:237], v[132:135]
    ds_read_b128 v[156:159], v9 offset:5120
    s_waitcnt lgkmcnt(3)
    v_mfma_f32_16x16x32_bf16 v[116:119], v[136:139], v[16:19], v[116:119]
    ds_read_b128 v[160:163], v9 offset:6144
    v_mfma_f32_16x16x32_bf16 v[120:123], v[140:143], v[16:19], v[120:123]
    ds_read_b128 v[164:167], v9 offset:7168
    v_mfma_f32_16x16x32_bf16 v[124:127], v[144:147], v[16:19], v[124:127]
    buffer_load_dwordx2 v[52:53], v253, s[28:31], s55 offen offset:1024 sc1
    buffer_load_dwordx2 v[54:55], v253, s[28:31], s55 offen offset:1536 sc1
    s_waitcnt vmcnt(6)
    v_max_u32 v92, v20, v21
    v_max3_u32 v92, v22, v23, v92
    ds_read_b128 v[168:171], v9 offset:8192
    s_waitcnt lgkmcnt(4)
    v_mfma_f32_16x16x32_bf16 v[128:131], v[148:151], v[16:19], v[128:131]
    v_cmp_eq_u32 vcc, 4290772991, v92
    s_cbranch_vccnz L_retryA1
L_goodA1:
    ds_read_b128 v[172:175], v9 offset:9216
    v_mfma_f32_16x16x32_bf16 v[132:135], v[152:155], v[16:19], v[132:135]
    ds_read_b128 v[136:139], v9 offset:10240
    s_waitcnt lgkmcnt(3)
    v_mfma_f32_16x16x32_bf16 v[116:119], v[156:159], v[20:23], v[116:119]
    buffer_load_dwordx4 v[32:35], v2, s[28:31], s54 offen offset:0 sc1
    ds_read_b128 v[140:143], v9 offset:11264
    v_mfma_f32_16x16x32_bf16 v[120:123], v[160:163], v[20:23], v[120:123]
    ds_read_b128 v[144:147], v9 offset:12288
    v_mfma_f32_16x16x32_bf16 v[124:127], v[164:167], v[20:23], v[124:127]
    s_waitcnt vmcnt(4)
    v_max_u32 v92, v24, v25
    v_max3_u32 v92, v26, v27, v92
    ds_read_b128 v[148:151], v9 offset:13312
    s_waitcnt lgkmcnt(4)
    v_mfma_f32_16x16x32_bf16 v[128:131], v[168:171], v[20:23], v[128:131]
    v_cmp_eq_u32 vcc, 4290772991, v92
    s_cbranch_vccnz L_retryA2
L_goodA2:
    ds_read_b128 v[152:155], v9 offset:14336
    v_mfma_f32_16x16x32_bf16 v[132:135], v[172:175], v[20:23], v[132:135]
    buffer_load_dwordx4 v[36:39], v2, s[28:31], s54 offen offset:1024 sc1
    ds_read_b128 v[156:159], v9 offset:15360
    s_waitcnt lgkmcnt(3)
    v_mfma_f32_16x16x32_bf16 v[116:119], v[136:139], v[24:27], v[116:119]
    ds_read_b128 v[160:163], v9 offset:16384
    v_mfma_f32_16x16x32_bf16 v[120:123], v[140:143], v[24:27], v[120:123]
    ds_read_b128 v[164:167], v9 offset:17408
    v_mfma_f32_16x16x32_bf16 v[124:127], v[144:147], v[24:27], v[124:127]
    buffer_load_dwordx4 v[40:43], v2, s[28:31], s54 offen offset:2048 sc1
    s_waitcnt vmcnt(5)
    v_max_u32 v92, v28, v29
    v_max3_u32 v92, v30, v31, v92
    ds_read_b128 v[168:171], v9 offset:18432
    s_waitcnt lgkmcnt(4)
    v_mfma_f32_16x16x32_bf16 v[128:131], v[148:151], v[24:27], v[128:131]
    v_cmp_eq_u32 vcc, 4290772991, v92
    s_cbranch_vccnz L_retryA3
L_goodA3:
    ds_read_b128 v[172:175], v9 offset:19456
    v_mfma_f32_16x16x32_bf16 v[132:135], v[152:155], v[24:27], v[132:135]
    ds_read_b128 v[136:139], v11 offset:1024
    s_waitcnt lgkmcnt(3)
    v_mfma_f32_16x16x32_bf16 v[116:119], v[156:159], v[28:31], v[116:119]
    ds_read_b128 v[140:143], v11 offset:2048
    v_mfma_f32_16x16x32_bf16 v[120:123], v[160:163], v[28:31], v[120:123]
    buffer_load_dwordx4 v[44:47], v2, s[28:31], s54 offen offset:3072 sc1
    ds_read_b128 v[144:147], v11 offset:3072
    v_mfma_f32_16x16x32_bf16 v[124:127], v[164:167], v[28:31], v[124:127]
    s_waitcnt vmcnt(4)
    v_max_u32 v92, v52, v53
    v_max3_u32 v92, v54, v55, v92
    ds_read_b128 v[148:151], v11 offset:4096
    s_waitcnt lgkmcnt(4)
    v_mfma_f32_16x16x32_bf16 v[128:131], v[168:171], v[28:31], v[128:131]
    v_cmp_eq_u32 vcc, 4290772991, v92
    s_cbranch_vccnz L_retryA4
L_goodA4:
    ds_read_b128 v[152:155], v11 offset:5120
    v_mfma_f32_16x16x32_bf16 v[132:135], v[172:175], v[28:31], v[132:135]
    s_waitcnt vmcnt(8)
    s_barrier
    buffer_load_dwordx2 v[48:49], v253, s[28:31], s55 offen offset:0 sc1
    buffer_load_dwordx2 v[50:51], v253, s[28:31], s55 offen offset:512 sc1
    ds_read_b128 v[156:159], v8 offset:0
    s_waitcnt lgkmcnt(3)
    v_mfma_f32_16x16x32_bf16 v[116:119], v[136:139], v[52:55], v[116:119]
    ds_read_b128 v[160:163], v8 offset:1024
    v_mfma_f32_16x16x32_bf16 v[120:123], v[140:143], v[52:55], v[120:123]
    ds_read_b128 v[164:167], v8 offset:2048
    v_mfma_f32_16x16x32_bf16 v[124:127], v[144:147], v[52:55], v[124:127]
    s_waitcnt vmcnt(5)
    v_max_u32 v92, v32, v33
    v_max3_u32 v92, v34, v35, v92
    ds_read_b128 v[168:171], v8 offset:3072
    s_waitcnt lgkmcnt(4)
    v_mfma_f32_16x16x32_bf16 v[128:131], v[148:151], v[52:55], v[128:131]
    v_cmp_eq_u32 vcc, 4290772991, v92
    s_cbranch_vccnz L_retryA5
L_goodA5:
    ds_read_b128 v[172:175], v8 offset:4096
    v_mfma_f32_16x16x32_bf16 v[132:135], v[152:155], v[52:55], v[132:135]
    s_cmp_lt_u32 s3, 4
    s_cbranch_scc1 L_f1
    ds_read_b128 v[136:139], v8 offset:8192
    s_waitcnt lgkmcnt(3)
    v_mfma_f32_16x16x32_bf16 v[116:119], v[156:159], v[32:35], v[116:119]
    ds_read_b128 v[140:143], v8 offset:9216
    v_mfma_f32_16x16x32_bf16 v[120:123], v[160:163], v[32:35], v[120:123]
    ds_read_b128 v[144:147], v8 offset:13312
    v_mfma_f32_16x16x32_bf16 v[124:127], v[164:167], v[32:35], v[124:127]
    s_waitcnt vmcnt(4)
    v_max_u32 v92, v36, v37
    v_max3_u32 v92, v38, v39, v92
    ds_read_b128 v[148:151], v8 offset:14336
    s_waitcnt lgkmcnt(4)
    v_mfma_f32_16x16x32_bf16 v[128:131], v[168:171], v[32:35], v[128:131]
    v_cmp_eq_u32 vcc, 4290772991, v92
    s_cbranch_vccnz L_retryA6a
L_goodA6a:
    ds_read_b128 v[152:155], v8 offset:18432
    v_mfma_f32_16x16x32_bf16 v[132:135], v[172:175], v[32:35], v[132:135]
    s_waitcnt vmcnt(3)
    v_max_u32 v92, v40, v41
    v_max3_u32 v92, v42, v43, v92
    ds_read_b128 v[156:159], v8 offset:19456
    s_waitcnt lgkmcnt(3)
    v_mfma_f32_16x16x32_bf16 v[128:131], v[136:139], v[36:39], v[128:131]
    v_cmp_eq_u32 vcc, 4290772991, v92
    s_cbranch_vccnz L_retryA7a
L_goodA7a:
    ds_read_b128 v[160:163], v8 offset:23552
    v_mfma_f32_16x16x32_bf16 v[132:135], v[140:143], v[36:39], v[132:135]
    s_waitcnt vmcnt(2)
    v_max_u32 v92, v44, v45
    v_max3_u32 v92, v46, v47, v92
    ds_read_b128 v[164:167], v11 offset:0
    v_mfma_f32_16x16x32_bf16 v[128:131], v[144:147], v[40:43], v[128:131]
    v_cmp_eq_u32 vcc, 4290772991, v92
    s_cbranch_vccnz L_retryA8a
L_goodA8a:
    ds_read_b128 v[168:171], v8 offset:5120
    s_waitcnt lgkmcnt(4)
    v_mfma_f32_16x16x32_bf16 v[132:135], v[148:151], v[40:43], v[132:135]
    s_waitcnt vmcnt(0)
    v_max_u32 v92, v48, v49
    v_max3_u32 v92, v50, v51, v92
    ds_read_b128 v[172:175], v8 offset:10240
    v_mfma_f32_16x16x32_bf16 v[128:131], v[152:155], v[44:47], v[128:131]
    v_cmp_eq_u32 vcc, 4290772991, v92
    s_cbranch_vccnz L_retryA9a
L_goodA9a:
    ds_read_b128 v[136:139], v8 offset:15360
    s_waitcnt lgkmcnt(3)
    v_mfma_f32_16x16x32_bf16 v[132:135], v[156:159], v[44:47], v[132:135]
    ds_read_b128 v[140:143], v8 offset:20480
    v_mfma_f32_16x16x32_bf16 v[128:131], v[160:163], v[48:51], v[128:131]
    ds_read_b128 v[144:147], v8 offset:6144
    v_mfma_f32_16x16x32_bf16 v[132:135], v[164:167], v[48:51], v[132:135]
    ds_read_b128 v[148:151], v8 offset:11264
    s_waitcnt lgkmcnt(4)
    v_mfma_f32_16x16x32_bf16 v[116:119], v[168:171], v[36:39], v[116:119]
    ds_read_b128 v[152:155], v8 offset:16384
    v_mfma_f32_16x16x32_bf16 v[116:119], v[172:175], v[40:43], v[116:119]
    s_nop 3
    ds_write_b128 v10, v[128:131] offset:3072
    ds_write_b128 v10, v[132:135] offset:4096
    ds_read_b128 v[156:159], v8 offset:21504
    s_waitcnt lgkmcnt(5)
    v_mfma_f32_16x16x32_bf16 v[116:119], v[136:139], v[44:47], v[116:119]
    ds_read_b128 v[160:163], v8 offset:7168
    v_mfma_f32_16x16x32_bf16 v[116:119], v[140:143], v[48:51], v[116:119]
    s_waitcnt lgkmcnt(2)
    s_barrier
    ds_read_b128 v[198:201], v10 offset:0
    ds_read_b128 v[202:205], v10 offset:1024
    ds_read_b128 v[206:209], v10 offset:2048
    ds_read_b128 v[164:167], v8 offset:12288
    v_mfma_f32_16x16x32_bf16 v[120:123], v[144:147], v[36:39], v[120:123]
    ds_read_b128 v[168:171], v8 offset:17408
    v_mfma_f32_16x16x32_bf16 v[120:123], v[148:151], v[40:43], v[120:123]
    ds_read_b128 v[172:175], v8 offset:22528
    v_mfma_f32_16x16x32_bf16 v[120:123], v[152:155], v[44:47], v[120:123]
    s_waitcnt lgkmcnt(2)
    v_mfma_f32_16x16x32_bf16 v[120:123], v[156:159], v[48:51], v[120:123]
    v_mfma_f32_16x16x32_bf16 v[124:127], v[160:163], v[36:39], v[124:127]
    v_mfma_f32_16x16x32_bf16 v[124:127], v[164:167], v[40:43], v[124:127]
    v_pk_add_f32 v[116:117], v[116:117], v[198:199]
    v_pk_add_f32 v[118:119], v[118:119], v[200:201]
    v_cvt_pk_bf16_f32 v60, v116, v117
    v_cvt_pk_bf16_f32 v61, v118, v119
    s_waitcnt lgkmcnt(0)
    v_mfma_f32_16x16x32_bf16 v[124:127], v[168:171], v[44:47], v[124:127]
    v_mfma_f32_16x16x32_bf16 v[124:127], v[172:175], v[48:51], v[124:127]
    s_nop 3
    v_pk_add_f32 v[120:121], v[120:121], v[202:203]
    v_pk_add_f32 v[122:123], v[122:123], v[204:205]
    v_cvt_pk_bf16_f32 v62, v120, v121
    v_cvt_pk_bf16_f32 v63, v122, v123
    buffer_store_dwordx4 v[60:63], v14, s[60:63], s57 offen offset:0
    v_pk_add_f32 v[124:125], v[124:125], v[206:207]
    v_pk_add_f32 v[126:127], v[126:127], v[208:209]
    v_cvt_pk_bf16_f32 v64, v124, v125
    v_cvt_pk_bf16_f32 v65, v126, v127
    buffer_store_dwordx2 v[64:65], v254, s[60:63], s58 offen
    s_endpgm
L_f1:
    ds_read_b128 v[136:139], v8 offset:5120
    s_waitcnt lgkmcnt(3)
    v_mfma_f32_16x16x32_bf16 v[116:119], v[156:159], v[32:35], v[116:119]
    ds_read_b128 v[140:143], v8 offset:6144
    v_mfma_f32_16x16x32_bf16 v[120:123], v[160:163], v[32:35], v[120:123]
    ds_read_b128 v[144:147], v8 offset:7168
    v_mfma_f32_16x16x32_bf16 v[124:127], v[164:167], v[32:35], v[124:127]
    s_waitcnt vmcnt(4)
    v_max_u32 v92, v36, v37
    v_max3_u32 v92, v38, v39, v92
    ds_read_b128 v[148:151], v8 offset:10240
    s_waitcnt lgkmcnt(4)
    v_mfma_f32_16x16x32_bf16 v[128:131], v[168:171], v[32:35], v[128:131]
    v_cmp_eq_u32 vcc, 4290772991, v92
    s_cbranch_vccnz L_retryA6b
L_goodA6b:
    ds_read_b128 v[152:155], v8 offset:11264
    v_mfma_f32_16x16x32_bf16 v[132:135], v[172:175], v[32:35], v[132:135]
    ds_read_b128 v[156:159], v8 offset:12288
    s_waitcnt lgkmcnt(3)
    v_mfma_f32_16x16x32_bf16 v[116:119], v[136:139], v[36:39], v[116:119]
    s_waitcnt vmcnt(3)
    v_max_u32 v92, v40, v41
    v_max3_u32 v92, v42, v43, v92
    ds_read_b128 v[160:163], v8 offset:15360
    v_mfma_f32_16x16x32_bf16 v[120:123], v[140:143], v[36:39], v[120:123]
    v_cmp_eq_u32 vcc, 4290772991, v92
    s_cbranch_vccnz L_retryA7b
L_goodA7b:
    ds_read_b128 v[164:167], v8 offset:16384
    v_mfma_f32_16x16x32_bf16 v[124:127], v[144:147], v[36:39], v[124:127]
    ds_read_b128 v[168:171], v8 offset:17408
    s_waitcnt lgkmcnt(4)
    v_mfma_f32_16x16x32_bf16 v[116:119], v[148:151], v[40:43], v[116:119]
    s_waitcnt vmcnt(2)
    v_max_u32 v92, v44, v45
    v_max3_u32 v92, v46, v47, v92
    ds_read_b128 v[172:175], v8 offset:20480
    v_mfma_f32_16x16x32_bf16 v[120:123], v[152:155], v[40:43], v[120:123]
    v_cmp_eq_u32 vcc, 4290772991, v92
    s_cbranch_vccnz L_retryA8b
L_goodA8b:
    ds_read_b128 v[136:139], v8 offset:21504
    s_waitcnt lgkmcnt(3)
    v_mfma_f32_16x16x32_bf16 v[124:127], v[156:159], v[40:43], v[124:127]
    ds_read_b128 v[140:143], v8 offset:22528
    v_mfma_f32_16x16x32_bf16 v[116:119], v[160:163], v[44:47], v[116:119]
    s_waitcnt vmcnt(0)
    v_max_u32 v92, v48, v49
    v_max3_u32 v92, v50, v51, v92
    ds_read_b128 v[144:147], v8 offset:8192
    v_mfma_f32_16x16x32_bf16 v[120:123], v[164:167], v[44:47], v[120:123]
    v_cmp_eq_u32 vcc, 4290772991, v92
    s_cbranch_vccnz L_retryA9b
L_goodA9b:
    ds_read_b128 v[148:151], v8 offset:13312
    s_waitcnt lgkmcnt(4)
    v_mfma_f32_16x16x32_bf16 v[124:127], v[168:171], v[44:47], v[124:127]
    ds_read_b128 v[152:155], v8 offset:18432
    v_mfma_f32_16x16x32_bf16 v[116:119], v[172:175], v[48:51], v[116:119]
    ds_read_b128 v[156:159], v8 offset:23552
    s_waitcnt lgkmcnt(3)
    v_mfma_f32_16x16x32_bf16 v[120:123], v[136:139], v[48:51], v[120:123]
    ds_read_b128 v[160:163], v8 offset:9216
    v_mfma_f32_16x16x32_bf16 v[124:127], v[140:143], v[48:51], v[124:127]
    ds_read_b128 v[164:167], v8 offset:14336
    v_mfma_f32_16x16x32_bf16 v[128:131], v[144:147], v[36:39], v[128:131]
    ds_read_b128 v[168:171], v8 offset:19456
    s_waitcnt lgkmcnt(4)
    v_mfma_f32_16x16x32_bf16 v[128:131], v[148:151], v[40:43], v[128:131]
    s_nop 3
    ds_write_b128 v10, v[116:119] offset:0
    ds_write_b128 v10, v[120:123] offset:1024
    ds_write_b128 v10, v[124:127] offset:2048
    ds_read_b128 v[172:175], v11 offset:0
    v_mfma_f32_16x16x32_bf16 v[128:131], v[152:155], v[44:47], v[128:131]
    s_waitcnt lgkmcnt(5)
    v_mfma_f32_16x16x32_bf16 v[128:131], v[156:159], v[48:51], v[128:131]
    s_waitcnt lgkmcnt(1)
    s_barrier
    ds_read_b128 v[198:201], v10 offset:3072
    ds_read_b128 v[202:205], v10 offset:4096
    v_mfma_f32_16x16x32_bf16 v[132:135], v[160:163], v[36:39], v[132:135]
    v_mfma_f32_16x16x32_bf16 v[132:135], v[164:167], v[40:43], v[132:135]
    s_waitcnt lgkmcnt(2)
    v_mfma_f32_16x16x32_bf16 v[132:135], v[168:171], v[44:47], v[132:135]
    v_mfma_f32_16x16x32_bf16 v[132:135], v[172:175], v[48:51], v[132:135]
    s_nop 3
    s_waitcnt lgkmcnt(1)
    v_pk_add_f32 v[128:129], v[128:129], v[198:199]
    v_pk_add_f32 v[130:131], v[130:131], v[200:201]
    v_cvt_pk_bf16_f32 v60, v128, v129
    v_cvt_pk_bf16_f32 v61, v130, v131
    s_waitcnt lgkmcnt(0)
    v_pk_add_f32 v[132:133], v[132:133], v[202:203]
    v_pk_add_f32 v[134:135], v[134:135], v[204:205]
    v_cvt_pk_bf16_f32 v62, v132, v133
    v_cvt_pk_bf16_f32 v63, v134, v135
    buffer_store_dwordx4 v[60:63], v14, s[60:63], s57 offen offset:64
    s_endpgm
L_o7:
    s_mov_b32 s50, 29458432
    s_mov_b32 s51, 400000
L_poll3:
    buffer_load_dwordx2 v[14:15], v240, s[28:31], s50 offen sc1
L_pollw3:
    s_waitcnt vmcnt(0)
    v_cmp_ne_u64 vcc, s[48:49], v[14:15]
    s_sub_u32 s51, s51, 1
    s_cbranch_scc1 L_polled3
    s_cbranch_vccz L_polled3
    s_mov_b64 exec, vcc
    s_sleep 1
    s_branch L_poll3
L_polled3:
    s_mov_b64 exec, -1
    s_branch L_a7
L_psa0:
    s_nop 0
    v_mov_b64 v[132:133], v[192:193]
    v_mov_b64 v[134:135], v[194:195]
    v_mov_b64 v[136:137], v[196:197]
    v_mov_b64 v[138:139], v[198:199]
    v_mov_b64 v[140:141], v[200:201]
    v_mov_b64 v[142:143], v[202:203]
    v_mov_b64 v[144:145], v[204:205]
    v_mov_b64 v[146:147], v[206:207]
    v_mov_b64 v[148:149], v[208:209]
    v_mov_b64 v[150:151], v[210:211]
    s_call_b64 s[26:27], L_phislow
    s_branch L_pra0
L_psb0:
    s_nop 0
    v_mov_b64 v[132:133], v[198:199]
    v_mov_b64 v[134:135], v[200:201]
    v_mov_b64 v[136:137], v[202:203]
    v_mov_b64 v[138:139], v[204:205]
    v_mov_b64 v[140:141], v[206:207]
    v_mov_b64 v[142:143], v[208:209]
    v_mov_b64 v[144:145], v[210:211]
    v_mov_b64 v[146:147], v[212:213]
    v_mov_b64 v[148:149], v[214:215]
    v_mov_b64 v[150:151], v[216:217]
    s_call_b64 s[26:27], L_phislow
    s_branch L_prb0
L_psb1:
    s_nop 0
    v_mov_b64 v[132:133], v[172:173]
    v_mov_b64 v[134:135], v[174:175]
    v_mov_b64 v[136:137], v[176:177]
    v_mov_b64 v[138:139], v[178:179]
    v_mov_b64 v[140:141], v[180:181]
    v_mov_b64 v[142:143], v[182:183]
    v_mov_b64 v[144:145], v[184:185]
    v_mov_b64 v[146:147], v[186:187]
    v_mov_b64 v[148:149], v[188:189]
    v_mov_b64 v[150:151], v[190:191]
    s_call_b64 s[26:27], L_phislow
    s_branch L_prb1
L_psa1:
    s_nop 0
    v_mov_b64 v[132:133], v[212:213]
    v_mov_b64 v[134:135], v[214:215]
    v_mov_b64 v[136:137], v[216:217]
    v_mov_b64 v[138:139], v[218:219]
    v_mov_b64 v[140:141], v[220:221]
    v_mov_b64 v[142:143], v[222:223]
    v_mov_b64 v[144:145], v[224:225]
    v_mov_b64 v[146:147], v[226:227]
    v_mov_b64 v[148:149], v[228:229]
    v_mov_b64 v[150:151], v[230:231]
    s_call_b64 s[26:27], L_phislow
    s_branch L_pra1
L_phislow:
    v_max_f32 v11, v132, v133
    v_min_f32 v12, v132, v133
    v_max3_f32 v11, v134, v135, v11
    v_min3_f32 v12, v134, v135, v12
    v_max3_f32 v11, v136, v137, v11
    v_min3_f32 v12, v136, v137, v12
    v_max3_f32 v11, v138, v139, v11
    v_min3_f32 v12, v138, v139, v12
    v_max3_f32 v11, v140, v141, v11
    v_min3_f32 v12, v140, v141, v12
    v_max3_f32 v11, v142, v143, v11
    v_min3_f32 v12, v142, v143, v12
    v_max3_f32 v11, v144, v145, v11
    v_min3_f32 v12, v144, v145, v12
    v_max3_f32 v11, v146, v147, v11
    v_min3_f32 v12, v146, v147, v12
    v_max3_f32 v11, v148, v149, v11
    v_min3_f32 v12, v148, v149, v12
    v_max3_f32 v11, v150, v151, v11
    v_min3_f32 v12, v150, v151, v12
    v_sub_f32 v112, v12, v132
    v_sub_f32 v132, v132, v11
    v_sub_f32 v113, v12, v133
    v_sub_f32 v133, v133, v11
    v_sub_f32 v114, v12, v134
    v_sub_f32 v134, v134, v11
    v_sub_f32 v115, v12, v135
    v_sub_f32 v135, v135, v11
    v_sub_f32 v116, v12, v136
    v_sub_f32 v136, v136, v11
    v_sub_f32 v117, v12, v137
    v_sub_f32 v137, v137, v11
    v_sub_f32 v118, v12, v138
    v_sub_f32 v138, v138, v11
    v_sub_f32 v119, v12, v139
    v_sub_f32 v139, v139, v11
    v_sub_f32 v120, v12, v140
    v_sub_f32 v140, v140, v11
    v_sub_f32 v121, v12, v141
    v_sub_f32 v141, v141, v11
    v_sub_f32 v122, v12, v142
    v_sub_f32 v142, v142, v11
    v_sub_f32 v123, v12, v143
    v_sub_f32 v143, v143, v11
    v_sub_f32 v124, v12, v144
    v_sub_f32 v144, v144, v11
    v_sub_f32 v125, v12, v145
    v_sub_f32 v145, v145, v11
    v_sub_f32 v126, v12, v146
    v_sub_f32 v146, v146, v11
    v_sub_f32 v127, v12, v147
    v_sub_f32 v147, v147, v11
    v_sub_f32 v128, v12, v148
    v_sub_f32 v148, v148, v11
    v_sub_f32 v129, v12, v149
    v_sub_f32 v149, v149, v11
    v_sub_f32 v130, v12, v150
    v_sub_f32 v150, v150, v11
    v_sub_f32 v131, v12, v151
    v_sub_f32 v151, v151, v11
    v_exp_f32 v112, v112
    v_exp_f32 v132, v132
    v_exp_f32 v113, v113
    v_exp_f32 v133, v133
    v_exp_f32 v114, v114
    v_exp_f32 v134, v134
    v_exp_f32 v115, v115
    v_exp_f32 v135, v135
    v_exp_f32 v116, v116
    v_exp_f32 v136, v136
    v_exp_f32 v117, v117
    v_exp_f32 v137, v137
    v_exp_f32 v118, v118
    v_exp_f32 v138, v138
    v_exp_f32 v119, v119
    v_exp_f32 v139, v139
    v_exp_f32 v120, v120
    v_exp_f32 v140, v140
    v_exp_f32 v121, v121
    v_exp_f32 v141, v141
    v_exp_f32 v122, v122
    v_exp_f32 v142, v142
    v_exp_f32 v123, v123
    v_exp_f32 v143, v143
    v_exp_f32 v124, v124
    v_exp_f32 v144, v144
    v_exp_f32 v125, v125
    v_exp_f32 v145, v145
    v_exp_f32 v126, v126
    v_exp_f32 v146, v146
    v_exp_f32 v127, v127
    v_exp_f32 v147, v147
    v_exp_f32 v128, v128
    v_exp_f32 v148, v148
    v_exp_f32 v129, v129
    v_exp_f32 v149, v149
    v_exp_f32 v130, v130
    v_exp_f32 v150, v150
    v_exp_f32 v131, v131
    v_exp_f32 v151, v151
    s_setpc_b64 s[26:27]
L_retryB0:
    s_cmp_eq_u32 s51, 0
    s_cbranch_scc1 L_goodB0
    s_sub_u32 s51, s51, 1
    s_add_u32 s50, s52, 0
    buffer_load_dwordx4 v[198:201], v2, s[28:31], s50 offen offset:0 sc1
    buffer_load_dwordx4 v[202:205], v2, s[28:31], s50 offen offset:1024 sc1
    buffer_load_dwordx4 v[206:209], v2, s[28:31], s50 offen offset:2048 sc1
    buffer_load_dwordx4 v[210:213], v2, s[28:31], s50 offen offset:3072 sc1
    s_add_u32 s50, s52, 4096
    buffer_load_dwordx4 v[214:217], v2, s[28:31], s50 offen offset:0 sc1
    buffer_load_dwordx4 v[218:221], v2, s[28:31], s50 offen offset:1024 sc1
    buffer_load_dwordx4 v[222:225], v2, s[28:31], s50 offen offset:2048 sc1
    buffer_load_dwordx4 v[226:229], v2, s[28:31], s50 offen offset:3072 sc1
    s_add_u32 s50, s52, 8192
    buffer_load_dwordx2 v[230:231], v253, s[28:31], s50 offen offset:0 sc1
    buffer_load_dwordx2 v[232:233], v253, s[28:31], s50 offen offset:512 sc1
    buffer_load_dwordx2 v[234:235], v253, s[28:31], s50 offen offset:1024 sc1
    buffer_load_dwordx2 v[236:237], v253, s[28:31], s50 offen offset:1536 sc1
    s_waitcnt vmcnt(0)
    v_max_u32 v92, v198, v199
    v_max3_u32 v92, v200, v201, v92
    v_max3_u32 v92, v202, v203, v92
    v_max3_u32 v92, v204, v205, v92
    v_cmp_eq_u32 vcc, 4290772991, v92
    s_cbranch_vccnz L_retryB0
    s_branch L_goodB0
L_retryB1:
    s_cmp_eq_u32 s51, 0
    s_cbranch_scc1 L_goodB1
    s_sub_u32 s51, s51, 1
    s_add_u32 s50, s52, 0
    buffer_load_dwordx4 v[206:209], v2, s[28:31], s50 offen offset:2048 sc1
    buffer_load_dwordx4 v[210:213], v2, s[28:31], s50 offen offset:3072 sc1
    s_add_u32 s50, s52, 4096
    buffer_load_dwordx4 v[214:217], v2, s[28:31], s50 offen offset:0 sc1
    buffer_load_dwordx4 v[218:221], v2, s[28:31], s50 offen offset:1024 sc1
    buffer_load_dwordx4 v[222:225], v2, s[28:31], s50 offen offset:2048 sc1
    buffer_load_dwordx4 v[226:229], v2, s[28:31], s50 offen offset:3072 sc1
    s_add_u32 s50, s52, 8192
    buffer_load_dwordx2 v[230:231], v253, s[28:31], s50 offen offset:0 sc1
    buffer_load_dwordx2 v[232:233], v253, s[28:31], s50 offen offset:512 sc1
    buffer_load_dwordx2 v[234:235], v253, s[28:31], s50 offen offset:1024 sc1
    buffer_load_dwordx2 v[236:237], v253, s[28:31], s50 offen offset:1536 sc1
    s_waitcnt vmcnt(0)
    v_max_u32 v92, v206, v207
    v_max3_u32 v92, v208, v209, v92
    v_max3_u32 v92, v210, v211, v92
    v_max3_u32 v92, v212, v213, v92
    v_cmp_eq_u32 vcc, 4290772991, v92
    s_cbranch_vccnz L_retryB1
    s_branch L_goodB1
L_retryB2:
    s_cmp_eq_u32 s51, 0
    s_cbranch_scc1 L_goodB2
    s_sub_u32 s51, s51, 1
    s_add_u32 s50, s52, 4096
    buffer_load_dwordx4 v[214:217], v2, s[28:31], s50 offen offset:0 sc1
    buffer_load_dwordx4 v[218:221], v2, s[28:31], s50 offen offset:1024 sc1
    buffer_load_dwordx4 v[222:225], v2, s[28:31], s50 offen offset:2048 sc1
    buffer_load_dwordx4 v[226:229], v2, s[28:31], s50 offen offset:3072 sc1
    s_add_u32 s50, s52, 8192
    buffer_load_dwordx2 v[230:231], v253, s[28:31], s50 offen offset:0 sc1
    buffer_load_dwordx2 v[232:233], v253, s[28:31], s50 offen offset:512 sc1
    buffer_load_dwordx2 v[234:235], v253, s[28:31], s50 offen offset:1024 sc1
    buffer_load_dwordx2 v[236:237], v253, s[28:31], s50 offen offset:1536 sc1
    s_waitcnt vmcnt(0)
    v_max_u32 v92, v214, v215
    v_max3_u32 v92, v216, v217, v92
    v_max3_u32 v92, v218, v219, v92
    v_max3_u32 v92, v220, v221, v92
    v_cmp_eq_u32 vcc, 4290772991, v92
    s_cbranch_vccnz L_retryB2
    s_branch L_goodB2
L_retryB3:
    s_cmp_eq_u32 s51, 0
    s_cbranch_scc1 L_goodB3
    s_sub_u32 s51, s51, 1
    s_add_u32 s50, s52, 4096
    buffer_load_dwordx4 v[222:225], v2, s[28:31], s50 offen offset:2048 sc1
    buffer_load_dwordx4 v[226:229], v2, s[28:31], s50 offen offset:3072 sc1
    s_add_u32 s50, s52, 8192
    buffer_load_dwordx2 v[230:231], v253, s[28:31], s50 offen offset:0 sc1
    buffer_load_dwordx2 v[232:233], v253, s[28:31], s50 offen offset:512 sc1
    buffer_load_dwordx2 v[234:235], v253, s[28:31], s50 offen offset:1024 sc1
    buffer_load_dwordx2 v[236:237], v253, s[28:31], s50 offen offset:1536 sc1
    s_waitcnt vmcnt(0)
    v_max_u32 v92, v222, v223
    v_max3_u32 v92, v224, v225, v92
    v_max3_u32 v92, v226, v227, v92
    v_max3_u32 v92, v228, v229, v92
    v_cmp_eq_u32 vcc, 4290772991, v92
    s_cbranch_vccnz L_retryB3
    s_branch L_goodB3
L_retryB4:
    s_cmp_eq_u32 s51, 0
    s_cbranch_scc1 L_goodB4
    s_sub_u32 s51, s51, 1
    s_add_u32 s50, s52, 8192
    buffer_load_dwordx2 v[230:231], v253, s[28:31], s50 offen offset:0 sc1
    buffer_load_dwordx2 v[232:233], v253, s[28:31], s50 offen offset:512 sc1
    buffer_load_dwordx2 v[234:235], v253, s[28:31], s50 offen offset:1024 sc1
    buffer_load_dwordx2 v[236:237], v253, s[28:31], s50 offen offset:1536 sc1
    s_waitcnt vmcnt(0)
    v_max_u32 v92, v230, v231
    v_max3_u32 v92, v232, v233, v92
    v_max3_u32 v92, v234, v235, v92
    v_max3_u32 v92, v236, v237, v92
    v_cmp_eq_u32 vcc, 4290772991, v92
    s_cbranch_vccnz L_retryB4
    s_branch L_goodB4
L_retryA0:
    s_cmp_eq_u32 s51, 0
    s_cbranch_scc1 L_goodA0
    s_sub_u32 s51, s51, 1
    s_waitcnt vmcnt(0)
    s_call_b64 s[26:27], L_ref0
    v_max_u32 v92, v16, v17
    v_max3_u32 v92, v18, v19, v92
    v_cmp_eq_u32 vcc, 4290772991, v92
    s_cbranch_vccnz L_retryA0
    s_branch L_goodA0
L_retryA1:
    s_cmp_eq_u32 s51, 0
    s_cbranch_scc1 L_goodA1
    s_sub_u32 s51, s51, 1
    s_waitcnt vmcnt(0)
    s_call_b64 s[26:27], L_ref1
    v_max_u32 v92, v20, v21
    v_max3_u32 v92, v22, v23, v92
    v_cmp_eq_u32 vcc, 4290772991, v92
    s_cbranch_vccnz L_retryA1
    s_branch L_goodA1
L_retryA2:
    s_cmp_eq_u32 s51, 0
    s_cbranch_scc1 L_goodA2
    s_sub_u32 s51, s51, 1
    s_waitcnt vmcnt(0)
    s_call_b64 s[26:27], L_ref2
    v_max_u32 v92, v24, v25
    v_max3_u32 v92, v26, v27, v92
    v_cmp_eq_u32 vcc, 4290772991, v92
    s_cbranch_vccnz L_retryA2
    s_branch L_goodA2
L_retryA3:
    s_cmp_eq_u32 s51, 0
    s_cbranch_scc1 L_goodA3
    s_sub_u32 s51, s51, 1
    s_waitcnt vmcnt(0)
    s_call_b64 s[26:27], L_ref3
    v_max_u32 v92, v28, v29
    v_max3_u32 v92, v30, v31, v92
    v_cmp_eq_u32 vcc, 4290772991, v92
    s_cbranch_vccnz L_retryA3
    s_branch L_goodA3
L_retryA4:
    s_cmp_eq_u32 s51, 0
    s_cbranch_scc1 L_goodA4
    s_sub_u32 s51, s51, 1
    s_waitcnt vmcnt(0)
    s_call_b64 s[26:27], L_ref4
    v_max_u32 v92, v52, v53
    v_max3_u32 v92, v54, v55, v92
    v_cmp_eq_u32 vcc, 4290772991, v92
    s_cbranch_vccnz L_retryA4
    s_branch L_goodA4
L_retryA5:
    s_cmp_eq_u32 s51, 0
    s_cbranch_scc1 L_goodA5
    s_sub_u32 s51, s51, 1
    s_waitcnt vmcnt(0)
    s_call_b64 s[26:27], L_ref5
    v_max_u32 v92, v32, v33
    v_max3_u32 v92, v34, v35, v92
    v_cmp_eq_u32 vcc, 4290772991, v92
    s_cbranch_vccnz L_retryA5
    s_branch L_goodA5
L_retryA6a:
    s_cmp_eq_u32 s51, 0
    s_cbranch_scc1 L_goodA6a
    s_sub_u32 s51, s51, 1
    s_waitcnt vmcnt(0)
    s_call_b64 s[26:27], L_ref6
    v_max_u32 v92, v36, v37
    v_max3_u32 v92, v38, v39, v92
    v_cmp_eq_u32 vcc, 4290772991, v92
    s_cbranch_vccnz L_retryA6a
    s_branch L_goodA6a
L_retryA7a:
    s_cmp_eq_u32 s51, 0
    s_cbranch_scc1 L_goodA7a
    s_sub_u32 s51, s51, 1
    s_waitcnt vmcnt(0)
    s_call_b64 s[26:27], L_ref7
    v_max_u32 v92, v40, v41
    v_max3_u32 v92, v42, v43, v92
    v_cmp_eq_u32 vcc, 4290772991, v92
    s_cbranch_vccnz L_retryA7a
    s_branch L_goodA7a
L_retryA8a:
    s_cmp_eq_u32 s51, 0
    s_cbranch_scc1 L_goodA8a
    s_sub_u32 s51, s51, 1
    s_waitcnt vmcnt(0)
    s_call_b64 s[26:27], L_ref8
    v_max_u32 v92, v44, v45
    v_max3_u32 v92, v46, v47, v92
    v_cmp_eq_u32 vcc, 4290772991, v92
    s_cbranch_vccnz L_retryA8a
    s_branch L_goodA8a
L_retryA9a:
    s_cmp_eq_u32 s51, 0
    s_cbranch_scc1 L_goodA9a
    s_sub_u32 s51, s51, 1
    s_waitcnt vmcnt(0)
    s_call_b64 s[26:27], L_ref9
    v_max_u32 v92, v48, v49
    v_max3_u32 v92, v50, v51, v92
    v_cmp_eq_u32 vcc, 4290772991, v92
    s_cbranch_vccnz L_retryA9a
    s_branch L_goodA9a
L_retryA6b:
    s_cmp_eq_u32 s51, 0
    s_cbranch_scc1 L_goodA6b
    s_sub_u32 s51, s51, 1
    s_waitcnt vmcnt(0)
    s_call_b64 s[26:27], L_ref6
    v_max_u32 v92, v36, v37
    v_max3_u32 v92, v38, v39, v92
    v_cmp_eq_u32 vcc, 4290772991, v92
    s_cbranch_vccnz L_retryA6b
    s_branch L_goodA6b
L_retryA7b:
    s_cmp_eq_u32 s51, 0
    s_cbranch_scc1 L_goodA7b
    s_sub_u32 s51, s51, 1
    s_waitcnt vmcnt(0)
    s_call_b64 s[26:27], L_ref7
    v_max_u32 v92, v40, v41
    v_max3_u32 v92, v42, v43, v92
    v_cmp_eq_u32 vcc, 4290772991, v92
    s_cbranch_vccnz L_retryA7b
    s_branch L_goodA7b
L_retryA8b:
    s_cmp_eq_u32 s51, 0
    s_cbranch_scc1 L_goodA8b
    s_sub_u32 s51, s51, 1
    s_waitcnt vmcnt(0)
    s_call_b64 s[26:27], L_ref8
    v_max_u32 v92, v44, v45
    v_max3_u32 v92, v46, v47, v92
    v_cmp_eq_u32 vcc, 4290772991, v92
    s_cbranch_vccnz L_retryA8b
    s_branch L_goodA8b
L_retryA9b:
    s_cmp_eq_u32 s51, 0
    s_cbranch_scc1 L_goodA9b
    s_sub_u32 s51, s51, 1
    s_waitcnt vmcnt(0)
    s_call_b64 s[26:27], L_ref9
    v_max_u32 v92, v48, v49
    v_max3_u32 v92, v50, v51, v92
    v_cmp_eq_u32 vcc, 4290772991, v92
    s_cbranch_vccnz L_retryA9b
    s_branch L_goodA9b
L_ref0:
    v_max_u32 v92, v16, v17
    v_max3_u32 v92, v18, v19, v92
    v_cmp_eq_u32 vcc, 4290772991, v92
    s_mov_b64 exec, vcc
    buffer_load_dwordx4 v[16:19], v2, s[28:31], s68 offen offset:0 sc1
    s_mov_b64 exec, -1
L_ref1:
    v_max_u32 v92, v20, v21
    v_max3_u32 v92, v22, v23, v92
    v_cmp_eq_u32 vcc, 4290772991, v92
    s_mov_b64 exec, vcc
    buffer_load_dwordx4 v[20:23], v2, s[28:31], s68 offen offset:1024 sc1
    s_mov_b64 exec, -1
L_ref2:
    v_max_u32 v92, v24, v25
    v_max3_u32 v92, v26, v27, v92
    v_cmp_eq_u32 vcc, 4290772991, v92
    s_mov_b64 exec, vcc
    buffer_load_dwordx4 v[24:27], v2, s[28:31], s68 offen offset:2048 sc1
    s_mov_b64 exec, -1
L_ref3:
    v_max_u32 v92, v28, v29
    v_max3_u32 v92, v30, v31, v92
    v_cmp_eq_u32 vcc, 4290772991, v92
    s_mov_b64 exec, vcc
    buffer_load_dwordx4 v[28:31], v2, s[28:31], s68 offen offset:3072 sc1
    s_mov_b64 exec, -1
L_ref4:
    v_max_u32 v92, v52, v53
    v_max3_u32 v92, v54, v55, v92
    v_cmp_eq_u32 vcc, 4290772991, v92
    s_mov_b64 exec, vcc
    buffer_load_dwordx2 v[52:53], v253, s[28:31], s55 offen offset:1024 sc1
    buffer_load_dwordx2 v[54:55], v253, s[28:31], s55 offen offset:1536 sc1
    s_mov_b64 exec, -1
L_ref5:
    v_max_u32 v92, v32, v33
    v_max3_u32 v92, v34, v35, v92
    v_cmp_eq_u32 vcc, 4290772991, v92
    s_mov_b64 exec, vcc
    buffer_load_dwordx4 v[32:35], v2, s[28:31], s54 offen offset:0 sc1
    s_mov_b64 exec, -1
L_ref6:
    v_max_u32 v92, v36, v37
    v_max3_u32 v92, v38, v39, v92
    v_cmp_eq_u32 vcc, 4290772991, v92
    s_mov_b64 exec, vcc
    buffer_load_dwordx4 v[36:39], v2, s[28:31], s54 offen offset:1024 sc1
    s_mov_b64 exec, -1
L_ref7:
    v_max_u32 v92, v40, v41
    v_max3_u32 v92, v42, v43, v92
    v_cmp_eq_u32 vcc, 4290772991, v92
    s_mov_b64 exec, vcc
    buffer_load_dwordx4 v[40:43], v2, s[28:31], s54 offen offset:2048 sc1
    s_mov_b64 exec, -1
L_ref8:
    v_max_u32 v92, v44, v45
    v_max3_u32 v92, v46, v47, v92
    v_cmp_eq_u32 vcc, 4290772991, v92
    s_mov_b64 exec, vcc
    buffer_load_dwordx4 v[44:47], v2, s[28:31], s54 offen offset:3072 sc1
    s_mov_b64 exec, -1
L_ref9:
    v_max_u32 v92, v48, v49
    v_max3_u32 v92, v50, v51, v92
    v_cmp_eq_u32 vcc, 4290772991, v92
    s_mov_b64 exec, vcc
    buffer_load_dwordx2 v[48:49], v253, s[28:31], s55 offen offset:0 sc1
    buffer_load_dwordx2 v[50:51], v253, s[28:31], s55 offen offset:512 sc1
    s_mov_b64 exec, -1
    s_waitcnt vmcnt(0)
    s_setpc_b64 s[26:27]
L_xc:
    ds_read_b32 v14, v12 offset:48
    s_waitcnt lgkmcnt(0)
    v_cmp_ne_u32 vcc, 8, v14
    s_cbranch_vccnz L_xc
    s_branch L_xcr
L_xw:
    s_sleep 1
    ds_read_b32 v8, v81
    s_waitcnt lgkmcnt(0)
    v_cmp_eq_u32 vcc, 0, v8
    s_cbranch_vccnz L_xw
    ds_read_b128 v[16:19], v83 offset:0
    ds_read_b128 v[20:23], v83 offset:1024
    ds_read_b128 v[24:27], v83 offset:2048
    ds_read_b32 v28, v83 offset:3072
    s_branch L_xwr
L_fallback:
    v_mov_b32 v80, 4286578688
    s_mov_b32 s26, 0
L_fb_max:
    s_lshr_b32 s51, s26, 1
    s_mul_i32 s51, s51, 5632
    s_add_u32 s51, s51, s38
    s_add_u32 s51, s51, 6291456
    s_and_b32 s50, s26, 1
    s_mul_i32 s50, s50, s37
    s_lshl_b32 s54, s50, 10
    s_add_u32 s54, s54, s51
    s_lshl_b32 s55, s50, 8
    s_add_u32 s55, s55, s51
    s_mul_i32 s50, s50, 1536
    s_add_u32 s50, s50, s51
    buffer_load_dwordx4 v[172:175], v247, s[28:31], s54 offen sc1
    buffer_load_dwordx2 v[180:181], v248, s[28:31], s55 offen offset:2048 sc1
    s_waitcnt vmcnt(0)
    v_mfma_f32_32x32x16_bf16 v[16:31], v[172:175], v[160:163], 0
    v_mfma_f32_32x32x16_bf16 v[32:47], v[172:175], v[166:169], 0
    s_nop 9
    v_mfma_f32_32x32x4_2b_bf16 v[16:47], v[180:181], v[164:165], v[16:47]
    s_nop 15
    s_nop 3
    v_max3_f32 v80, v32, v33, v80
    v_max3_f32 v80, v34, v35, v80
    v_max3_f32 v80, v36, v37, v80
    v_max3_f32 v80, v38, v39, v80
    v_max3_f32 v80, v40, v41, v80
    v_max3_f32 v80, v42, v43, v80
    v_max3_f32 v80, v44, v45, v80
    v_max3_f32 v80, v46, v47, v80
    s_add_u32 s26, s26, 1
    s_cmp_lt_u32 s26, 64
    s_cbranch_scc1 L_fb_max
    v_mov_b32 v81, v80
    s_nop 1
    v_permlane32_swap_b32 v80, v81
    s_nop 1
    v_max_f32 v80, v80, v81
    v_sub_f32 v144, 0, v80
    v_sub_f32 v145, 0, v80
    v_mov_b64 v[146:147], v[144:145]
    v_mov_b64 v[148:149], v[144:145]
    v_mov_b64 v[150:151], v[144:145]
    v_mov_b64 v[152:153], v[144:145]
    v_mov_b64 v[154:155], v[144:145]
    v_mov_b64 v[156:157], v[144:145]
    v_mov_b64 v[158:159], v[144:145]
    v_mov_b32 v96, 0
    v_mov_b32 v97, 0
    v_mov_b32 v98, 0
    v_mov_b32 v99, 0
    v_mov_b32 v100, 0
    v_mov_b32 v101, 0
    v_mov_b32 v102, 0
    v_mov_b32 v103, 0
    v_mov_b32 v104, 0
    v_mov_b32 v105, 0
    v_mov_b32 v106, 0
    v_mov_b32 v107, 0
    v_mov_b32 v108, 0
    v_mov_b32 v109, 0
    v_mov_b32 v110, 0
    v_mov_b32 v111, 0
    s_mov_b32 s26, 0
L_fb_pv:
    s_lshr_b32 s51, s26, 1
    s_mul_i32 s51, s51, 5632
    s_add_u32 s51, s51, s38
    s_add_u32 s51, s51, 6291456
    s_and_b32 s50, s26, 1
    s_mul_i32 s50, s50, s37
    s_lshl_b32 s54, s50, 10
    s_add_u32 s54, s54, s51
    s_lshl_b32 s55, s50, 8
    s_add_u32 s55, s55, s51
    s_mul_i32 s50, s50, 1536
    s_add_u32 s50, s50, s51
    buffer_load_dwordx4 v[172:175], v247, s[28:31], s54 offen sc1
    buffer_load_dwordx2 v[180:181], v248, s[28:31], s55 offen offset:2048 sc1
    buffer_load_dwordx4 v[182:185], v249, s[28:31], s50 offen offset:0 sc1
    buffer_load_dwordx4 v[186:189], v249, s[28:31], s50 offen offset:768 sc1
    s_waitcnt vmcnt(0)
    v_mfma_f32_32x32x16_bf16 v[16:31], v[172:175], v[160:163], 0
    v_mfma_f32_32x32x16_bf16 v[32:47], v[172:175], v[166:169], v[144:159]
    s_nop 9
    v_mfma_f32_32x32x4_2b_bf16 v[16:47], v[180:181], v[164:165], v[16:47]
    s_nop 15
    s_nop 3
    v_exp_f32 v32, v32
    v_exp_f32 v33, v33
    v_exp_f32 v34, v34
    v_exp_f32 v35, v35
    v_exp_f32 v36, v36
    v_exp_f32 v37, v37
    v_exp_f32 v38, v38
    v_exp_f32 v39, v39
    v_exp_f32 v40, v40
    v_exp_f32 v41, v41
    v_exp_f32 v42, v42
    v_exp_f32 v43, v43
    v_exp_f32 v44, v44
    v_exp_f32 v45, v45
    v_exp_f32 v46, v46
    v_exp_f32 v47, v47
    s_nop 1
    v_smfmac_f32_32x32x32_bf16 v[96:111], v[182:185], v[32:39], v11
    v_smfmac_f32_32x32x32_bf16 v[96:111], v[186:189], v[40:47], v11
    s_nop 15
    s_add_u32 s26, s26, 1
    s_cmp_lt_u32 s26, 64
    s_cbranch_scc1 L_fb_pv
    s_mov_b64 s[56:57], 0
    s_mov_b64 s[58:59], 0
    s_mov_b64 vcc, 0
    s_branch L_fin
L_end:
    s_endpgm
L_codeend:
.section .rodata,"a"
.p2align 6
.amdhsa_kernel gated_mix__mha_block__linear_kernel_hedgehog__prompt_kernel
  .amdhsa_next_free_vgpr 256
  .amdhsa_next_free_sgpr 102
  .amdhsa_accum_offset 256
  .amdhsa_group_segment_fixed_size 0
  .amdhsa_kernarg_size 88
  .amdhsa_user_sgpr_count 2
  .amdhsa_user_sgpr_kernarg_segment_ptr 1
  .amdhsa_system_sgpr_workgroup_id_x 1
.end_amdhsa_kernel
```
